```python
import torch

def _softmax(x, axis=-1):
    return torch.softmax(x, dim=axis)
def _gelu(x):
    return torch.nn.functional.gelu(x, approximate="tanh")
def _silu(x):
    return torch.nn.functional.silu(x)
def _sigmoid(x):
    return torch.sigmoid(x)
def _layernorm(x, axis=-1, eps=1e-5):
    m = x.mean(dim=axis, keepdim=True)
    v = x.var(dim=axis, keepdim=True, unbiased=False)
    return (x - m) / torch.sqrt(v + eps)
def _scatter_add(tgt, idx, src, axis=0):
    return tgt.clone().index_add_(axis, idx, src)
def _segment_sum(src, seg, n):
    out = torch.zeros((n,) + src.shape[1:], dtype=src.dtype)
    return out.index_add_(0, seg, src)
def _pad(x, pw):
    flat = tuple(v for pair in reversed(pw) for v in pair)
    return torch.nn.functional.pad(x, flat)

kernel_name = 'gated_mix__compressed_kv_cla__glu_gated_glu__decode'

def setup_inputs():

    _w = (lambda a: (lambda t: t.to(torch.bfloat16) if t.is_floating_point() else t)(torch.as_tensor(a)))
    def _A_setup():
        B, H, Sq, Sk, D, M = 1, 32, 1, 8192, 192, 640
        Dc = 4 * D
        return {
            "x": _w((lambda *s: torch.randn(*s, dtype=torch.bfloat16) * 0.05)(B, Sq, M)),
            "c_kv": _w((lambda *s: torch.randn(*s, dtype=torch.bfloat16) * 1.6)(B, Sk, Dc)),
            "w_q": _w((lambda *s: torch.randn(*s, dtype=torch.bfloat16) * 3.2)(M, H, D) * (M ** -0.5)),
            "w_uk": _w((lambda *s: torch.randn(*s, dtype=torch.bfloat16) * 3.2)(Dc, H, D) * (Dc ** -0.5)),
            "w_uv": _w((lambda *s: torch.randn(*s, dtype=torch.bfloat16) * 1.6)(Dc, H, D) * (Dc ** -0.5)),
            "w_o": _w((lambda *s: torch.randn(*s, dtype=torch.bfloat16) * 1.6)(H, D, M) * ((H * D) ** -0.5)),
        }
    _A_in = _A_setup()

    def _B_setup():
        B, S, D, F = 1, 1, 640, 1536
        return {
            "x": _w((lambda *s: torch.randn(*s, dtype=torch.bfloat16) * 0.05)(B, S, D)),
            "w_gate": _w((lambda *s: torch.randn(*s, dtype=torch.bfloat16) * 1.6)(D, F)),
            "w_up": _w((lambda *s: torch.randn(*s, dtype=torch.bfloat16) * 0.05)(D, F)),
            "w_down": _w((lambda *s: torch.randn(*s, dtype=torch.bfloat16) * 0.05)(F, D)),
        }
    _B_in = _B_setup()

    return {
        "A_x": _A_in["x"],
        "A_c_kv": _A_in["c_kv"],
        "A_w_q": _A_in["w_q"],
        "A_w_uk": _A_in["w_uk"],
        "A_w_uv": _A_in["w_uv"],
        "A_w_o": _A_in["w_o"],
        "B_x": _B_in["x"],
        "B_w_gate": _B_in["w_gate"],
        "B_w_up": _B_in["w_up"],
        "B_w_down": _B_in["w_down"],
        "gate_w": _w((lambda *s: torch.randn(*s, dtype=torch.bfloat16) * 0.05)(640) * 16.0),
    }

def reference(A_x, A_c_kv, A_w_q, A_w_uk, A_w_uv, A_w_o, B_x, B_w_gate, B_w_up, B_w_down, gate_w):
    def _A_ref(x, c_kv, w_q, w_uk, w_uv, w_o):
        B, Sq, M = x.shape[0], x.shape[1], x.shape[2]
        Sk = c_kv.shape[1]
        H, D = w_q.shape[1], w_q.shape[2]
        q = torch.einsum("bqm,mhd->bhqd", x, w_q)
        k = torch.einsum("bkc,chd->bhkd", c_kv, w_uk)
        v = torch.einsum("bkc,chd->bhkd", c_kv, w_uv)
        scores = torch.einsum("bhqd,bhkd->bhqk", q, k) * (D ** -0.5)
        off = Sk - Sq
        qi = torch.arange(Sq)[:, None]
        kj = torch.arange(Sk)[None, :]
        cmask = kj <= (qi + off)
        scores = torch.where(cmask[None, None], scores, -1e9)
        p = _softmax(scores, axis=-1)
        ctx = torch.einsum("bhqk,bhkd->bhqd", p, v)
        return torch.einsum("bhqd,hdm->bqm", ctx, w_o)

    def _B_ref(x, w_gate, w_up, w_down):
        g = torch.einsum("bsd,df->bsf", x, w_gate)
        u = torch.einsum("bsd,df->bsf", x, w_up)
        h = _sigmoid(g) * u
        return torch.einsum("bsf,fd->bsd", h, w_down)

    x = A_x
    g = _sigmoid((x * gate_w).sum(-1, keepdims=True))
    a = _A_ref(x, A_c_kv, A_w_q, A_w_uk, A_w_uv, A_w_o)
    b = _B_ref(x, B_w_gate, B_w_up, B_w_down)
    return g * a + (1 - g) * b
```

```asm
; @launch grid=(256,1,1) block=(640,1,1) lds=163840
.amdgcn_target "amdgcn-amd-amdhsa--gfx950"
.text
.globl gated_mix__compressed_kv_cla__glu_gated_glu__decode_kernel
.p2align 8
.type gated_mix__compressed_kv_cla__glu_gated_glu__decode_kernel,@function
gated_mix__compressed_kv_cla__glu_gated_glu__decode_kernel:
KSTART:
  s_cmp_ge_u32 s2, 256
  s_cbranch_scc1 L_end
  s_load_dwordx2 s[12:13], s[0:1], 16
  s_load_dwordx2 s[16:17], s[0:1], 24
  s_load_dwordx2 s[44:45], s[0:1], 104
  s_load_dwordx2 s[52:53], s[0:1], 0
  v_lshrrev_b32 v9, 6, v0
  v_and_b32 v1, 63, v0
  v_readfirstlane_b32 s4, v9
  v_mov_b32 v10, 0
  v_lshlrev_b32 v11, 2, v1
  v_add_u32 v11, 163664, v11
  s_mov_b64 exec, 0xffffffff
  s_mov_b32 exec_hi, 0
  ds_write_b32 v11, v10
  s_mov_b64 exec, -1
  s_and_b32 s5, s2, 7
  s_lshr_b32 s6, s2, 3
  s_lshl_b32 s7, s5, 2
  s_lshr_b32 s62, s6, 3
  s_add_u32 s7, s7, s62
  s_and_b32 s8, s6, 7
  s_lshl_b32 s9, s5, 3
  s_lshr_b32 s62, s6, 2
  s_add_u32 s9, s9, s62
  s_and_b32 s10, s6, 3
  v_lshrrev_b32 v2, 4, v1
  v_and_b32 v3, 15, v1
  v_lshrrev_b32 v4, 2, v3
  v_and_b32 v5, 3, v1
  v_lshlrev_b32 v6, 4, v1
  v_mov_b32 v16, 1
  s_mov_b32 s46, 0x10000000
  s_mov_b32 s47, 0x00020000
  s_mov_b32 s14, 7864320
  s_mov_b32 s15, 0x00020000
  v_add_u32 v11, 0, v1
  v_mul_u32_u24 v10, 2731, v11
  v_lshrrev_b32 v10, 16, v10
  v_mul_u32_u24 v12, 24, v10
  v_sub_u32 v11, v11, v12
  v_and_b32 v12, 6, v10
  v_xor_b32 v11, v11, v12
  v_lshlrev_b32 v11, 4, v11
  v_mul_u32_u24 v10, 12288, v10
  v_add_u32 v82, v10, v11
  v_add_u32 v11, 64, v1
  v_mul_u32_u24 v10, 2731, v11
  v_lshrrev_b32 v10, 16, v10
  v_mul_u32_u24 v12, 24, v10
  v_sub_u32 v11, v11, v12
  v_and_b32 v12, 6, v10
  v_xor_b32 v11, v11, v12
  v_lshlrev_b32 v11, 4, v11
  v_mul_u32_u24 v10, 12288, v10
  v_add_u32 v83, v10, v11
  v_add_u32 v11, 128, v1
  v_mul_u32_u24 v10, 2731, v11
  v_lshrrev_b32 v10, 16, v10
  v_mul_u32_u24 v12, 24, v10
  v_sub_u32 v11, v11, v12
  v_and_b32 v12, 6, v10
  v_xor_b32 v11, v11, v12
  v_lshlrev_b32 v11, 4, v11
  v_mul_u32_u24 v10, 12288, v10
  v_add_u32 v84, v10, v11
  s_mul_i32 s62, s8, 983040
  s_mul_i32 s63, s7, 384
  s_add_u32 s62, s62, s63
  s_mul_i32 s64, s4, 98304
  s_add_u32 s62, s62, s64
  s_mul_i32 s70, s4, 3072
  s_waitcnt lgkmcnt(0)
  s_add_u32 m0, s70, 86016
  s_nop 0
  buffer_load_dwordx4 v82, s[12:15], s62 offen nt lds
  s_add_u32 m0, s70, 87040
  s_nop 0
  buffer_load_dwordx4 v83, s[12:15], s62 offen nt lds
  s_add_u32 m0, s70, 88064
  s_nop 0
  buffer_load_dwordx4 v84, s[12:15], s62 offen nt lds
  s_cmp_ge_u32 s4, 8
  s_cbranch_scc0 L_compute
  v_mov_b32 v99, 0
  v_mov_b32 v100, 163728
  s_load_dwordx2 s[20:21], s[0:1], 8
  s_load_dwordx2 s[24:25], s[0:1], 32
  s_load_dwordx2 s[28:29], s[0:1], 40
  s_load_dwordx2 s[32:33], s[0:1], 72
  s_load_dwordx2 s[40:41], s[0:1], 56
  s_load_dwordx2 s[42:43], s[0:1], 64
  s_sub_u32 s69, s4, 8
  s_mov_b32 s18, 9437184
  s_mov_b32 s19, 0x00020000
  s_mul_i32 s63, s7, 384
  s_mul_i32 s64, s69, 98304
  s_mul_i32 s70, s69, 3072
  s_mul_i32 s65, s8, 1179648
  s_add_u32 s65, s65, s63
  s_add_u32 s65, s65, s64
  s_waitcnt lgkmcnt(0)
  s_barrier
  s_add_u32 s63, s65, 0
  s_add_u32 m0, s70, 49152
  s_nop 0
  buffer_load_dwordx4 v82, s[16:19], s63 offen nt lds
  s_add_u32 m0, s70, 50176
  s_nop 0
  buffer_load_dwordx4 v83, s[16:19], s63 offen nt lds
  s_add_u32 m0, s70, 51200
  s_nop 0
  buffer_load_dwordx4 v84, s[16:19], s63 offen nt lds
  s_add_u32 s63, s65, 196608
  s_add_u32 m0, s70, 55296
  s_nop 0
  buffer_load_dwordx4 v82, s[16:19], s63 offen nt lds
  s_add_u32 m0, s70, 56320
  s_nop 0
  buffer_load_dwordx4 v83, s[16:19], s63 offen nt lds
  s_add_u32 m0, s70, 57344
  s_nop 0
  buffer_load_dwordx4 v84, s[16:19], s63 offen nt lds
  s_add_u32 s63, s65, 393216
  s_add_u32 m0, s70, 61440
  s_nop 0
  buffer_load_dwordx4 v82, s[16:19], s63 offen nt lds
  s_waitcnt vmcnt(9)
  s_add_u32 m0, s70, 62464
  s_nop 0
  buffer_load_dwordx4 v83, s[16:19], s63 offen nt lds
  s_waitcnt vmcnt(9)
  s_add_u32 m0, s70, 63488
  s_nop 0
  buffer_load_dwordx4 v84, s[16:19], s63 offen nt lds
  s_add_u32 s63, s65, 589824
  s_waitcnt vmcnt(9)
  v_mov_b32 v14, 163664
  s_mov_b64 exec, 1
  ds_add_u32 v14, v16
  s_mov_b64 exec, -1
  s_add_u32 m0, s70, 67584
  s_nop 0
  buffer_load_dwordx4 v82, s[16:19], s63 offen nt lds
  s_waitcnt vmcnt(9)
  s_add_u32 m0, s70, 68608
  s_nop 0
  buffer_load_dwordx4 v83, s[16:19], s63 offen nt lds
  s_waitcnt vmcnt(9)
  s_add_u32 m0, s70, 69632
  s_nop 0
  buffer_load_dwordx4 v84, s[16:19], s63 offen nt lds
  s_add_u32 s63, s65, 786432
  s_waitcnt vmcnt(9)
  s_add_u32 m0, s70, 73728
  s_nop 0
  buffer_load_dwordx4 v82, s[16:19], s63 offen nt lds
  s_waitcnt vmcnt(9)
  s_add_u32 m0, s70, 74752
  s_nop 0
  buffer_load_dwordx4 v83, s[16:19], s63 offen nt lds
  s_waitcnt vmcnt(9)
  s_add_u32 m0, s70, 75776
  s_nop 0
  buffer_load_dwordx4 v84, s[16:19], s63 offen nt lds
  s_add_u32 s63, s65, 983040
  s_waitcnt vmcnt(9)
  s_add_u32 m0, s70, 79872
  s_nop 0
  buffer_load_dwordx4 v82, s[16:19], s63 offen nt lds
  s_waitcnt vmcnt(9)
  s_add_u32 m0, s70, 80896
  s_nop 0
  buffer_load_dwordx4 v83, s[16:19], s63 offen nt lds
  s_waitcnt vmcnt(9)
  s_add_u32 m0, s70, 81920
  s_nop 0
  buffer_load_dwordx4 v84, s[16:19], s63 offen nt lds
  s_mov_b32 s22, 12582912
  s_mov_b32 s23, 0x00020000
  s_mov_b32 s26, 9437184
  s_mov_b32 s27, 0x00020000
  s_mov_b32 s30, 7864320
  s_mov_b32 s31, 0x00020000
  s_mov_b32 s34, 1966080
  s_mov_b32 s35, 0x00020000
  s_cmp_eq_u32 s69, 0
  s_cselect_b32 s36, s40, s42
  s_cselect_b32 s37, s41, s43
  s_mov_b32 s38, 1966080
  s_mov_b32 s39, 0x00020000
  v_add_u32 v11, 0, v1
  v_mul_u32_u24 v10, 2731, v11
  v_lshrrev_b32 v10, 16, v10
  v_mul_u32_u24 v12, 24, v10
  v_sub_u32 v11, v11, v12
  v_lshrrev_b32 v12, 3, v10
  v_and_b32 v12, 1, v12
  v_mul_u32_u24 v13, 5, v12
  v_and_b32 v12, 6, v10
  v_xor_b32 v12, v12, v13
  v_xor_b32 v11, v11, v12
  v_lshlrev_b32 v11, 4, v11
  v_mul_u32_u24 v10, 1536, v10
  v_add_u32 v85, v10, v11
  v_add_u32 v11, 64, v1
  v_mul_u32_u24 v10, 2731, v11
  v_lshrrev_b32 v10, 16, v10
  v_mul_u32_u24 v12, 24, v10
  v_sub_u32 v11, v11, v12
  v_lshrrev_b32 v12, 3, v10
  v_and_b32 v12, 1, v12
  v_mul_u32_u24 v13, 5, v12
  v_and_b32 v12, 6, v10
  v_xor_b32 v12, v12, v13
  v_xor_b32 v11, v11, v12
  v_lshlrev_b32 v11, 4, v11
  v_mul_u32_u24 v10, 1536, v10
  v_add_u32 v86, v10, v11
  v_add_u32 v11, 128, v1
  v_mul_u32_u24 v10, 2731, v11
  v_lshrrev_b32 v10, 16, v10
  v_mul_u32_u24 v12, 24, v10
  v_sub_u32 v11, v11, v12
  v_lshrrev_b32 v12, 3, v10
  v_and_b32 v12, 1, v12
  v_mul_u32_u24 v13, 5, v12
  v_and_b32 v12, 6, v10
  v_xor_b32 v12, v12, v13
  v_xor_b32 v11, v11, v12
  v_lshlrev_b32 v11, 4, v11
  v_mul_u32_u24 v10, 1536, v10
  v_add_u32 v87, v10, v11
  v_add_u32 v11, 192, v1
  v_mul_u32_u24 v10, 2731, v11
  v_lshrrev_b32 v10, 16, v10
  v_mul_u32_u24 v12, 24, v10
  v_sub_u32 v11, v11, v12
  v_lshrrev_b32 v12, 3, v10
  v_and_b32 v12, 1, v12
  v_mul_u32_u24 v13, 5, v12
  v_and_b32 v12, 6, v10
  v_xor_b32 v12, v12, v13
  v_xor_b32 v11, v11, v12
  v_lshlrev_b32 v11, 4, v11
  v_mul_u32_u24 v10, 1536, v10
  v_add_u32 v88, v10, v11
  v_add_u32 v11, 256, v1
  v_mul_u32_u24 v10, 2731, v11
  v_lshrrev_b32 v10, 16, v10
  v_mul_u32_u24 v12, 24, v10
  v_sub_u32 v11, v11, v12
  v_lshrrev_b32 v12, 3, v10
  v_and_b32 v12, 1, v12
  v_mul_u32_u24 v13, 5, v12
  v_and_b32 v12, 6, v10
  v_xor_b32 v12, v12, v13
  v_xor_b32 v11, v11, v12
  v_lshlrev_b32 v11, 4, v11
  v_mul_u32_u24 v10, 1536, v10
  v_add_u32 v89, v10, v11
  v_add_u32 v11, 320, v1
  v_mul_u32_u24 v10, 2731, v11
  v_lshrrev_b32 v10, 16, v10
  v_mul_u32_u24 v12, 24, v10
  v_sub_u32 v11, v11, v12
  v_lshrrev_b32 v12, 3, v10
  v_and_b32 v12, 1, v12
  v_mul_u32_u24 v13, 5, v12
  v_and_b32 v12, 6, v10
  v_xor_b32 v12, v12, v13
  v_xor_b32 v11, v11, v12
  v_lshlrev_b32 v11, 4, v11
  v_mul_u32_u24 v10, 1536, v10
  v_add_u32 v90, v10, v11
  v_add_u32 v11, 0, v1
  v_mul_u32_u24 v10, 6554, v11
  v_lshrrev_b32 v10, 16, v10
  v_mul_u32_u24 v12, 10, v10
  v_sub_u32 v11, v11, v12
  v_lshlrev_b32 v11, 4, v11
  v_mul_u32_u24 v10, 1280, v10
  v_add_u32 v91, v10, v11
  v_add_u32 v11, 64, v1
  v_mul_u32_u24 v10, 6554, v11
  v_lshrrev_b32 v10, 16, v10
  v_mul_u32_u24 v12, 10, v10
  v_sub_u32 v11, v11, v12
  v_lshlrev_b32 v11, 4, v11
  v_mul_u32_u24 v10, 1280, v10
  v_add_u32 v92, v10, v11
  v_add_u32 v11, 128, v1
  v_mul_u32_u24 v10, 6554, v11
  v_lshrrev_b32 v10, 16, v10
  v_mul_u32_u24 v12, 10, v10
  v_sub_u32 v11, v11, v12
  v_lshlrev_b32 v11, 4, v11
  v_mul_u32_u24 v10, 1280, v10
  v_add_u32 v93, v10, v11
  v_add_u32 v11, 192, v1
  v_mul_u32_u24 v10, 6554, v11
  v_lshrrev_b32 v10, 16, v10
  v_mul_u32_u24 v12, 10, v10
  v_sub_u32 v11, v11, v12
  v_lshlrev_b32 v11, 4, v11
  v_mul_u32_u24 v10, 1280, v10
  v_add_u32 v94, v10, v11
  v_add_u32 v11, 256, v1
  v_mul_u32_u24 v10, 6554, v11
  v_lshrrev_b32 v10, 16, v10
  v_mul_u32_u24 v12, 10, v10
  v_sub_u32 v11, v11, v12
  v_lshlrev_b32 v11, 4, v11
  v_mul_u32_u24 v10, 1280, v10
  v_add_u32 v95, v10, v11
  v_add_u32 v11, 0, v1
  v_mul_u32_u24 v10, 10923, v11
  v_lshrrev_b32 v10, 16, v10
  v_mul_u32_u24 v12, 6, v10
  v_sub_u32 v11, v11, v12
  v_lshlrev_b32 v11, 4, v11
  v_mul_u32_u24 v10, 3072, v10
  v_add_u32 v96, v10, v11
  v_add_u32 v11, 64, v1
  v_mul_u32_u24 v10, 10923, v11
  v_lshrrev_b32 v10, 16, v10
  v_mul_u32_u24 v12, 6, v10
  v_sub_u32 v11, v11, v12
  v_lshlrev_b32 v11, 4, v11
  v_mul_u32_u24 v10, 3072, v10
  v_add_u32 v97, v10, v11
  v_add_u32 v11, 128, v1
  v_mul_u32_u24 v10, 10923, v11
  v_lshrrev_b32 v10, 16, v10
  v_mul_u32_u24 v12, 6, v10
  v_sub_u32 v11, v11, v12
  v_lshlrev_b32 v11, 4, v11
  v_mul_u32_u24 v10, 3072, v10
  v_add_u32 v98, v10, v11
  s_cmp_eq_u32 s69, 0
  s_cselect_b32 s58, -1, 0
  s_cselect_b64 vcc, 0, -1
  v_add_u32 v10, 40960, v91
  v_add_u32 v11, 40960, v92
  v_add_u32 v12, 40960, v93
  v_cndmask_b32 v101, v91, v95, vcc
  v_cndmask_b32 v102, v92, v10, vcc
  v_cndmask_b32 v103, v93, v11, vcc
  v_cndmask_b32 v104, v94, v12, vcc
  s_lshl_b32 s62, s9, 7
  s_lshl_b32 s63, s69, 4
  s_add_u32 s62, s62, s63
  s_mul_i32 s62, s62, 1536
  s_mul_i32 s63, s10, 384
  s_add_u32 s62, s62, s63
  s_mul_i32 s64, s69, 6144
  s_add_u32 s63, s62, 0
  s_waitcnt vmcnt(9)
  s_add_u32 m0, s64, 0
  s_nop 0
  buffer_load_dwordx4 v85, s[20:23], s63 offen nt lds
  s_waitcnt vmcnt(9)
  s_add_u32 m0, s64, 1024
  s_nop 0
  buffer_load_dwordx4 v86, s[20:23], s63 offen nt lds
  s_waitcnt vmcnt(9)
  s_add_u32 m0, s64, 2048
  s_nop 0
  buffer_load_dwordx4 v87, s[20:23], s63 offen nt lds
  s_waitcnt vmcnt(9)
  s_add_u32 m0, s64, 3072
  s_nop 0
  buffer_load_dwordx4 v88, s[20:23], s63 offen nt lds
  s_waitcnt vmcnt(9)
  s_add_u32 m0, s64, 4096
  s_nop 0
  buffer_load_dwordx4 v89, s[20:23], s63 offen nt lds
  s_waitcnt vmcnt(9)
  s_add_u32 m0, s64, 5120
  s_nop 0
  buffer_load_dwordx4 v90, s[20:23], s63 offen nt lds
  s_add_u32 s63, s62, 49152
  s_waitcnt vmcnt(9)
  s_add_u32 m0, s64, 12288
  s_nop 0
  buffer_load_dwordx4 v85, s[20:23], s63 offen nt lds
  s_waitcnt vmcnt(9)
  s_add_u32 m0, s64, 13312
  s_nop 0
  buffer_load_dwordx4 v86, s[20:23], s63 offen nt lds
  s_waitcnt vmcnt(9)
  s_add_u32 m0, s64, 14336
  s_nop 0
  buffer_load_dwordx4 v87, s[20:23], s63 offen nt lds
  s_waitcnt vmcnt(9)
  v_mov_b32 v14, 163668
  s_mov_b64 exec, 1
  ds_add_u32 v14, v16
  s_mov_b64 exec, -1
  s_add_u32 m0, s64, 15360
  s_nop 0
  buffer_load_dwordx4 v88, s[20:23], s63 offen nt lds
  s_waitcnt vmcnt(9)
  s_add_u32 m0, s64, 16384
  s_nop 0
  buffer_load_dwordx4 v89, s[20:23], s63 offen nt lds
  s_waitcnt vmcnt(9)
  s_add_u32 m0, s64, 17408
  s_nop 0
  buffer_load_dwordx4 v90, s[20:23], s63 offen nt lds
  s_add_u32 s63, s62, 98304
  s_waitcnt vmcnt(9)
  s_add_u32 m0, s64, 24576
  s_nop 0
  buffer_load_dwordx4 v85, s[20:23], s63 offen nt lds
  s_waitcnt vmcnt(9)
  s_add_u32 m0, s64, 25600
  s_nop 0
  buffer_load_dwordx4 v86, s[20:23], s63 offen nt lds
  s_waitcnt vmcnt(9)
  s_add_u32 m0, s64, 26624
  s_nop 0
  buffer_load_dwordx4 v87, s[20:23], s63 offen nt lds
  s_waitcnt vmcnt(9)
  s_add_u32 m0, s64, 27648
  s_nop 0
  buffer_load_dwordx4 v88, s[20:23], s63 offen nt lds
  s_waitcnt vmcnt(9)
  s_add_u32 m0, s64, 28672
  s_nop 0
  buffer_load_dwordx4 v89, s[20:23], s63 offen nt lds
  s_waitcnt vmcnt(9)
  s_add_u32 m0, s64, 29696
  s_nop 0
  buffer_load_dwordx4 v90, s[20:23], s63 offen nt lds
  s_add_u32 s63, s62, 147456
  s_waitcnt vmcnt(9)
  s_add_u32 m0, s64, 36864
  s_nop 0
  buffer_load_dwordx4 v85, s[20:23], s63 offen nt lds
  s_waitcnt vmcnt(9)
  s_add_u32 m0, s64, 37888
  s_nop 0
  buffer_load_dwordx4 v86, s[20:23], s63 offen nt lds
  s_waitcnt vmcnt(9)
  s_add_u32 m0, s64, 38912
  s_nop 0
  buffer_load_dwordx4 v87, s[20:23], s63 offen nt lds
  s_waitcnt vmcnt(9)
  s_add_u32 m0, s64, 39936
  s_nop 0
  buffer_load_dwordx4 v88, s[20:23], s63 offen nt lds
  s_waitcnt vmcnt(9)
  s_add_u32 m0, s64, 40960
  s_nop 0
  buffer_load_dwordx4 v89, s[20:23], s63 offen nt lds
  s_waitcnt vmcnt(9)
  s_add_u32 m0, s64, 41984
  s_nop 0
  buffer_load_dwordx4 v90, s[20:23], s63 offen nt lds
  s_mul_i32 s62, s8, 245760
  s_mul_i32 s63, s7, 96
  s_add_u32 s62, s62, s63
  s_mul_i32 s64, s69, 7680
  s_add_u32 s63, s62, 0
  s_waitcnt vmcnt(9)
  s_add_u32 m0, s64, 124416
  s_nop 0
  buffer_load_dwordx4 v96, s[36:39], s63 offen nt lds
  s_waitcnt vmcnt(9)
  s_add_u32 m0, s64, 125440
  s_nop 0
  buffer_load_dwordx4 v97, s[36:39], s63 offen nt lds
  s_waitcnt vmcnt(9)
  s_add_u32 m0, s64, 126464
  s_nop 0
  buffer_load_dwordx4 v98, s[36:39], s63 offen nt lds
  s_add_u32 s63, s62, 98304
  s_waitcnt vmcnt(9)
  s_add_u32 m0, s64, 127488
  s_nop 0
  buffer_load_dwordx4 v96, s[36:39], s63 offen nt lds
  s_waitcnt vmcnt(9)
  s_add_u32 m0, s64, 128512
  s_nop 0
  buffer_load_dwordx4 v97, s[36:39], s63 offen nt lds
  s_waitcnt vmcnt(9)
  s_add_u32 m0, s64, 129536
  s_nop 0
  buffer_load_dwordx4 v98, s[36:39], s63 offen nt lds
  s_add_u32 s63, s62, 196608
  s_waitcnt vmcnt(9)
  s_add_u32 m0, s64, 130560
  s_nop 0
  buffer_load_dwordx4 v96, s[36:39], s63 offen nt lds
  s_waitcnt vmcnt(9)
  s_add_u32 m0, s64, 131584
  s_mov_b32 exec_hi, 0
  buffer_load_dwordx4 v97, s[36:39], s63 offen nt lds
  s_mov_b32 exec_hi, -1
  v_mov_b32 v14, 163664
L_wf_1:
  ds_read_b32 v15, v14 offset:16
  s_waitcnt lgkmcnt(0)
  v_cmp_gt_u32 vcc, 6, v15
  s_cbranch_vccnz L_wf_1
  s_mul_i32 s63, s7, 384
  s_mul_i32 s64, s69, 98304
  s_mul_i32 s65, s8, 1179648
  s_add_u32 s65, s65, s63
  s_add_u32 s65, s65, s64
  s_add_u32 s63, s65, 0
  s_waitcnt vmcnt(9)
  s_add_u32 m0, s70, 49152
  s_nop 0
  buffer_load_dwordx4 v82, s[24:27], s63 offen nt lds
  s_waitcnt vmcnt(9)
  v_mov_b32 v14, 163688
  s_mov_b64 exec, 1
  ds_add_u32 v14, v16
  s_mov_b64 exec, -1
  s_add_u32 m0, s70, 50176
  s_nop 0
  buffer_load_dwordx4 v83, s[24:27], s63 offen nt lds
  s_waitcnt vmcnt(9)
  s_add_u32 m0, s70, 51200
  s_nop 0
  buffer_load_dwordx4 v84, s[24:27], s63 offen nt lds
  s_add_u32 s63, s65, 196608
  s_waitcnt vmcnt(9)
  s_add_u32 m0, s70, 55296
  s_nop 0
  buffer_load_dwordx4 v82, s[24:27], s63 offen nt lds
  s_waitcnt vmcnt(9)
  s_add_u32 m0, s70, 56320
  s_nop 0
  buffer_load_dwordx4 v83, s[24:27], s63 offen nt lds
  s_waitcnt vmcnt(9)
  s_add_u32 m0, s70, 57344
  s_nop 0
  buffer_load_dwordx4 v84, s[24:27], s63 offen nt lds
  s_add_u32 s63, s65, 393216
  s_waitcnt vmcnt(9)
  s_add_u32 m0, s70, 61440
  s_nop 0
  buffer_load_dwordx4 v82, s[24:27], s63 offen nt lds
  s_waitcnt vmcnt(9)
  s_add_u32 m0, s70, 62464
  s_nop 0
  buffer_load_dwordx4 v83, s[24:27], s63 offen nt lds
  s_waitcnt vmcnt(9)
  s_add_u32 m0, s70, 63488
  s_nop 0
  buffer_load_dwordx4 v84, s[24:27], s63 offen nt lds
  s_add_u32 s63, s65, 589824
  s_waitcnt vmcnt(9)
  v_mov_b32 v14, 163744
  s_mov_b64 exec, 1
  ds_add_u32 v14, v16
  s_mov_b64 exec, -1
  s_add_u32 m0, s70, 67584
  s_nop 0
  buffer_load_dwordx4 v82, s[24:27], s63 offen nt lds
  s_waitcnt vmcnt(9)
  s_add_u32 m0, s70, 68608
  s_nop 0
  buffer_load_dwordx4 v83, s[24:27], s63 offen nt lds
  s_waitcnt vmcnt(9)
  s_add_u32 m0, s70, 69632
  s_nop 0
  buffer_load_dwordx4 v84, s[24:27], s63 offen nt lds
  s_add_u32 s63, s65, 786432
  s_waitcnt vmcnt(9)
  s_add_u32 m0, s70, 73728
  s_nop 0
  buffer_load_dwordx4 v82, s[24:27], s63 offen nt lds
  s_waitcnt vmcnt(9)
  s_add_u32 m0, s70, 74752
  s_nop 0
  buffer_load_dwordx4 v83, s[24:27], s63 offen nt lds
  s_waitcnt vmcnt(9)
  s_add_u32 m0, s70, 75776
  s_nop 0
  buffer_load_dwordx4 v84, s[24:27], s63 offen nt lds
  s_add_u32 s63, s65, 983040
  s_waitcnt vmcnt(9)
  s_add_u32 m0, s70, 79872
  s_nop 0
  buffer_load_dwordx4 v82, s[24:27], s63 offen nt lds
  s_waitcnt vmcnt(9)
  s_add_u32 m0, s70, 80896
  s_nop 0
  buffer_load_dwordx4 v83, s[24:27], s63 offen nt lds
  s_waitcnt vmcnt(9)
  s_add_u32 m0, s70, 81920
  s_nop 0
  buffer_load_dwordx4 v84, s[24:27], s63 offen nt lds
  v_mov_b32 v14, 163664
L_wf_2:
  ds_read_b32 v15, v14 offset:12
  s_waitcnt lgkmcnt(0)
  v_cmp_gt_u32 vcc, 4, v15
  s_cbranch_vccnz L_wf_2
  s_mul_i32 s62, s7, 245760
  s_mul_i32 s63, s8, 160
  s_add_u32 s62, s62, s63
  s_mul_i32 s64, s69, 40960
  s_add_u32 s62, s62, s64
  s_mul_i32 s65, s69, 5120
  s_add_u32 s63, s62, 0
  s_waitcnt vmcnt(9)
  s_add_u32 m0, s65, 86016
  s_nop 0
  buffer_load_dwordx4 v91, s[28:31], s63 offen nt lds
  s_waitcnt vmcnt(9)
  s_add_u32 m0, s65, 87040
  s_nop 0
  buffer_load_dwordx4 v92, s[28:31], s63 offen nt lds
  s_waitcnt vmcnt(9)
  s_add_u32 m0, s65, 88064
  s_nop 0
  buffer_load_dwordx4 v93, s[28:31], s63 offen nt lds
  s_waitcnt vmcnt(9)
  s_add_u32 m0, s65, 89088
  s_nop 0
  buffer_load_dwordx4 v94, s[28:31], s63 offen nt lds
  s_waitcnt vmcnt(9)
  s_add_u32 m0, s65, 90112
  s_nop 0
  buffer_load_dwordx4 v95, s[28:31], s63 offen nt lds
  s_add_u32 s63, s62, 81920
  s_waitcnt vmcnt(9)
  s_add_u32 m0, s65, 96256
  s_nop 0
  buffer_load_dwordx4 v91, s[28:31], s63 offen nt lds
  s_waitcnt vmcnt(9)
  s_add_u32 m0, s65, 97280
  s_nop 0
  buffer_load_dwordx4 v92, s[28:31], s63 offen nt lds
  s_waitcnt vmcnt(9)
  s_add_u32 m0, s65, 98304
  s_nop 0
  buffer_load_dwordx4 v93, s[28:31], s63 offen nt lds
  s_waitcnt vmcnt(9)
  s_add_u32 m0, s65, 99328
  s_nop 0
  buffer_load_dwordx4 v94, s[28:31], s63 offen nt lds
  s_waitcnt vmcnt(9)
  v_mov_b32 v14, 163708
  s_mov_b64 exec, 1
  ds_add_u32 v14, v16
  s_mov_b64 exec, -1
  s_add_u32 m0, s65, 100352
  s_nop 0
  buffer_load_dwordx4 v95, s[28:31], s63 offen nt lds
  s_add_u32 s63, s62, 163840
  s_waitcnt vmcnt(9)
  s_add_u32 m0, s65, 106496
  s_nop 0
  buffer_load_dwordx4 v91, s[28:31], s63 offen nt lds
  s_waitcnt vmcnt(9)
  s_add_u32 m0, s65, 107520
  s_nop 0
  buffer_load_dwordx4 v92, s[28:31], s63 offen nt lds
  s_waitcnt vmcnt(9)
  s_add_u32 m0, s65, 108544
  s_nop 0
  buffer_load_dwordx4 v93, s[28:31], s63 offen nt lds
  s_waitcnt vmcnt(9)
  s_add_u32 m0, s65, 109568
  s_nop 0
  buffer_load_dwordx4 v94, s[28:31], s63 offen nt lds
  s_waitcnt vmcnt(9)
  s_add_u32 m0, s65, 110592
  s_nop 0
  buffer_load_dwordx4 v95, s[28:31], s63 offen nt lds
  s_mul_i32 s62, s7, 61440
  s_mul_i32 s63, s8, 160
  s_add_u32 s63, s62, s63
  s_lshl_b32 s65, s69, 12
  s_waitcnt vmcnt(9)
  s_add_u32 m0, s65, 116736
  s_nop 0
  buffer_load_dwordx4 v101, s[32:35], s63 offen nt lds
  s_waitcnt vmcnt(9)
  s_add_u32 m0, s65, 117760
  s_nop 0
  buffer_load_dwordx4 v102, s[32:35], s63 offen nt lds
  s_waitcnt vmcnt(9)
  s_add_u32 m0, s65, 118784
  s_nop 0
  buffer_load_dwordx4 v103, s[32:35], s63 offen nt lds
  s_waitcnt vmcnt(9)
  s_add_u32 m0, s65, 119808
  s_mov_b32 exec_hi, s58
  buffer_load_dwordx4 v104, s[32:35], s63 offen nt lds
  s_mov_b32 exec_hi, -1
  s_waitcnt vmcnt(0)
  v_mov_b32 v14, 163716
  s_mov_b64 exec, 1
  ds_add_u32 v14, v16
  s_mov_b64 exec, -1
  s_endpgm
L_compute:
  s_load_dwordx2 s[56:57], s[0:1], 80
  s_load_dwordx2 s[48:49], s[0:1], 88
  s_mov_b32 s54, 1280
  s_mov_b32 s55, 0x00020000
  s_mov_b32 s58, 1280
  s_mov_b32 s59, 0x00020000
  s_mov_b32 s50, 1280
  s_mov_b32 s51, 0x00020000
  v_lshl_add_u32 v8, v2, 2, v4
  v_lshrrev_b32 v10, 1, v2
  v_lshlrev_b32 v10, 4, v10
  v_and_b32 v11, 1, v2
  v_lshl_add_u32 v10, v11, 2, v10
  v_add_u32 v7, v10, v4
  s_mul_i32 s62, s8, 160
  v_lshlrev_b32 v10, 3, v2
  v_add_u32 v10, s62, v10
  s_waitcnt lgkmcnt(0)
  s_load_dword s11, s[44:45], 0
  global_load_dwordx2 v[72:73], v10, s[52:53] offset:0
  global_load_dwordx2 v[74:75], v10, s[52:53] offset:32
  global_load_dwordx2 v[76:77], v10, s[52:53] offset:64
  global_load_dwordx2 v[78:79], v10, s[52:53] offset:96
  global_load_dwordx2 v[80:81], v10, s[52:53] offset:128
  s_barrier
  s_cmp_eq_u32 s4, 4
  s_cbranch_scc0 L_nogate
  buffer_load_dwordx4 v[88:91], v6, s[52:55], 0 offen
  buffer_load_dwordx4 v[92:95], v6, s[52:55], 0 offen offset:1024
  buffer_load_dwordx4 v[96:99], v6, s[56:59], 0 offen
  buffer_load_dwordx4 v[100:103], v6, s[56:59], 0 offen offset:1024
  s_waitcnt vmcnt(0)
  v_mov_b32 v10, 0
  v_dot2_f32_bf16 v10, v88, v96, v10
  v_dot2_f32_bf16 v10, v89, v97, v10
  v_dot2_f32_bf16 v10, v90, v98, v10
  v_dot2_f32_bf16 v10, v91, v99, v10
  v_dot2_f32_bf16 v10, v92, v100, v10
  v_dot2_f32_bf16 v10, v93, v101, v10
  v_dot2_f32_bf16 v10, v94, v102, v10
  v_dot2_f32_bf16 v10, v95, v103, v10
  s_nop 3
  s_nop 1
  v_add_f32_dpp v10, v10, v10 row_ror:8 row_mask:0xf bank_mask:0xf
  s_nop 1
  v_add_f32_dpp v10, v10, v10 row_ror:4 row_mask:0xf bank_mask:0xf
  s_nop 1
  v_add_f32_dpp v10, v10, v10 row_ror:2 row_mask:0xf bank_mask:0xf
  s_nop 1
  v_add_f32_dpp v10, v10, v10 row_ror:1 row_mask:0xf bank_mask:0xf
  v_mov_b32 v11, v10
  s_nop 1
  v_permlane16_swap_b32 v10, v11
  s_nop 1
  v_add_f32 v10, v10, v11
  v_mov_b32 v11, v10
  s_nop 1
  v_permlane32_swap_b32 v10, v11
  s_nop 1
  v_add_f32 v10, v10, v11
  v_mul_f32 v10, 0xbfb8aa3b, v10
  v_exp_f32 v10, v10
  s_nop 0
  v_add_f32 v10, 1.0, v10
  v_rcp_f32 v10, v10
  v_mov_b32 v11, 163328
  s_nop 0
  ds_write_b32 v11, v10
  v_mov_b32 v14, 163720
  s_mov_b64 exec, 1
  ds_add_u32 v14, v16
  s_mov_b64 exec, -1
L_nogate:
  s_waitcnt lgkmcnt(0)
  s_add_u32 s11, s11, 1
  s_cmp_lt_u32 s4, 4
  s_cbranch_scc1 L_s1
  s_waitcnt vmcnt(0)
  v_mov_b32 v14, 163664
  s_mov_b64 exec, 1
  ds_add_u32 v14, v16
  s_mov_b64 exec, -1
  s_cmp_eq_u32 s4, 7
  s_cbranch_scc0 L_noxid
  s_getreg_b32 s62, hwreg(HW_REG_XCC_ID)
  s_and_b32 s62, s62, 0xf
  v_mov_b32 v20, s62
  v_mov_b32 v21, 0
  v_mov_b32 v22, 0
  v_mov_b32 v23, s11
  s_lshl_b32 s63, s5, 9
  s_add_u32 s63, s63, 589824
  s_lshl_b32 s64, s6, 4
  s_add_u32 s64, s64, s63
  v_mov_b32 v10, 0
  s_mov_b64 exec, 1
  buffer_store_dwordx4 v[20:23], v10, s[44:47], s64 offen sc1
  s_mov_b64 exec, -1
  s_waitcnt vmcnt(0)
  v_and_b32 v10, 31, v1
  v_lshlrev_b32 v11, 4, v10
  s_mov_b32 s68, 200000
  buffer_load_dwordx4 v[36:39], v11, s[44:47], s63 offen sc1
  s_branch L_xid_w
L_xid:
  v_cmp_ne_u32 vcc, s11, v39
  buffer_load_dwordx4 v[36:39], v11, s[44:47], s63 offen sc1
L_xid_w:
  s_waitcnt vmcnt(0)
  v_xor_b32 v9, s11, v39
  v_cmp_ne_u32 vcc, 0, v9
  s_cbranch_vccz L_xid_ok
  s_sub_u32 s68, s68, 1
  s_cbranch_scc0 L_xid
L_xid_ok:
  v_cmp_ne_u32 vcc, s62, v36
  s_mov_b32 s64, 1
  s_cbranch_vccz L_xid_loc
  s_mov_b32 s64, 2
L_xid_loc:
  v_mov_b32 v10, s64
  v_mov_b32 v14, 163732
  ds_write_b32 v14, v10
L_noxid:
  s_branch L_s1_skip
L_s1:
  v_and_b32 v11, 6, v8
  v_mul_u32_u24 v10, 384, v8
  v_and_b32 v12, 1, v5
  v_lshl_add_u32 v10, v12, 3, v10
  v_add_u32 v10, 86016, v10
  v_lshrrev_b32 v12, 1, v5
  s_mul_i32 s62, s4, 6
  s_add_u32 s63, s62, 0
  v_add_u32 v13, s63, v12
  v_xor_b32 v13, v13, v11
  v_lshl_add_u32 v82, v13, 4, v10
  s_add_u32 s63, s62, 2
  v_add_u32 v13, s63, v12
  v_xor_b32 v13, v13, v11
  v_lshl_add_u32 v83, v13, 4, v10
  s_add_u32 s63, s62, 4
  v_add_u32 v13, s63, v12
  v_xor_b32 v13, v13, v11
  v_lshl_add_u32 v84, v13, 4, v10
  s_lshl_b32 s62, s7, 3
  s_add_u32 s62, s62, s8
  s_lshl_b32 s62, s62, 10
  s_lshl_b32 s63, s4, 8
  s_add_u32 s62, s62, s63
  s_add_u32 s64, s62, 4096
  s_waitcnt vmcnt(0)
  v_mov_b32 v14, 163664
  s_mov_b64 exec, 1
  ds_add_u32 v14, v16
  s_mov_b64 exec, -1
  v_mov_b32 v14, 163664
L_wf_3:
  ds_read_b32 v15, v14 offset:0
  s_waitcnt lgkmcnt(0)
  v_cmp_gt_u32 vcc, 10, v15
  s_cbranch_vccnz L_wf_3
  ds_read_b64_tr_b16 v[86:87], v82 offset:0
  ds_read_b64_tr_b16 v[88:89], v83 offset:0
  ds_read_b64_tr_b16 v[90:91], v84 offset:0
  ds_read_b64_tr_b16 v[92:93], v82 offset:6144
  ds_read_b64_tr_b16 v[94:95], v83 offset:6144
  ds_read_b64_tr_b16 v[96:97], v84 offset:6144
  ds_read_b64_tr_b16 v[98:99], v82 offset:12288
  ds_read_b64_tr_b16 v[100:101], v83 offset:12288
  ds_read_b64_tr_b16 v[102:103], v84 offset:12288
  ds_read_b64_tr_b16 v[104:105], v82 offset:18432
  ds_read_b64_tr_b16 v[106:107], v83 offset:18432
  ds_read_b64_tr_b16 v[108:109], v84 offset:18432
  ds_read_b64_tr_b16 v[110:111], v82 offset:24576
  ds_read_b64_tr_b16 v[112:113], v83 offset:24576
  ds_read_b64_tr_b16 v[114:115], v84 offset:24576
  s_waitcnt lgkmcnt(12)
  v_mfma_f32_16x16x16_bf16 v[24:27], v[72:73], v[86:87], 0
  v_mfma_f32_16x16x16_bf16 v[28:31], v[72:73], v[88:89], 0
  v_mfma_f32_16x16x16_bf16 v[32:35], v[72:73], v[90:91], 0
  s_waitcnt lgkmcnt(9)
  v_mfma_f32_16x16x16_bf16 v[24:27], v[74:75], v[92:93], v[24:27]
  v_mfma_f32_16x16x16_bf16 v[28:31], v[74:75], v[94:95], v[28:31]
  v_mfma_f32_16x16x16_bf16 v[32:35], v[74:75], v[96:97], v[32:35]
  s_waitcnt lgkmcnt(6)
  v_mfma_f32_16x16x16_bf16 v[24:27], v[76:77], v[98:99], v[24:27]
  v_mfma_f32_16x16x16_bf16 v[28:31], v[76:77], v[100:101], v[28:31]
  v_mfma_f32_16x16x16_bf16 v[32:35], v[76:77], v[102:103], v[32:35]
  s_waitcnt lgkmcnt(3)
  v_mfma_f32_16x16x16_bf16 v[24:27], v[78:79], v[104:105], v[24:27]
  v_mfma_f32_16x16x16_bf16 v[28:31], v[78:79], v[106:107], v[28:31]
  v_mfma_f32_16x16x16_bf16 v[32:35], v[78:79], v[108:109], v[32:35]
  s_waitcnt lgkmcnt(0)
  v_mfma_f32_16x16x16_bf16 v[24:27], v[80:81], v[110:111], v[24:27]
  v_mfma_f32_16x16x16_bf16 v[28:31], v[80:81], v[112:113], v[28:31]
  v_mfma_f32_16x16x16_bf16 v[32:35], v[80:81], v[114:115], v[32:35]
  s_cmp_eq_u32 s4, 0
  s_cbranch_scc0 L_np1
L_np1:
  v_mov_b32 v23, s11
  s_nop 7
  v_mov_b32 v20, v24
  v_mov_b32 v21, v28
  v_mov_b32 v22, v32
  s_mov_b64 exec, 0xffff
  buffer_store_dwordx4 v[20:23], v6, s[44:47], s64 offen sc1
  s_mov_b64 exec, -1
  v_mov_b32 v14, 163676
  s_mov_b64 exec, 1
  ds_add_u32 v14, v16
  s_mov_b64 exec, -1
  s_cmp_eq_u32 s4, 0
  s_cbranch_scc0 L_s1_skip
  s_lshl_b32 s62, s7, 13
  s_add_u32 s62, s62, 4096
  s_add_u32 s63, s62, 4096
  v_mul_u32_u24 v10, 96, v2
  v_lshl_add_u32 v10, v3, 1, v10
  v_add_u32 v10, 155136, v10
  s_waitcnt vmcnt(0)
  s_mov_b32 s68, 200000
  buffer_load_dwordx4 v[36:39], v6, s[44:47], s62 offen offset:0 sc1
  buffer_load_dwordx4 v[40:43], v6, s[44:47], s62 offen offset:1024 sc1
  buffer_load_dwordx4 v[44:47], v6, s[44:47], s62 offen offset:2048 sc1
  buffer_load_dwordx4 v[48:51], v6, s[44:47], s62 offen offset:3072 sc1
  buffer_load_dwordx4 v[52:55], v6, s[44:47], s63 offen offset:0 sc1
  buffer_load_dwordx4 v[56:59], v6, s[44:47], s63 offen offset:1024 sc1
  buffer_load_dwordx4 v[60:63], v6, s[44:47], s63 offen offset:2048 sc1
  buffer_load_dwordx4 v[64:67], v6, s[44:47], s63 offen offset:3072 sc1
  s_branch L_h1_w
L_h1:
  v_cmp_ne_u32 vcc, s11, v39
  s_cbranch_vccz L_h1_s0
  buffer_load_dwordx4 v[36:39], v6, s[44:47], s62 offen offset:0 sc1
L_h1_s0:
  v_cmp_ne_u32 vcc, s11, v43
  s_cbranch_vccz L_h1_s1
  buffer_load_dwordx4 v[40:43], v6, s[44:47], s62 offen offset:1024 sc1
L_h1_s1:
  v_cmp_ne_u32 vcc, s11, v47
  s_cbranch_vccz L_h1_s2
  buffer_load_dwordx4 v[44:47], v6, s[44:47], s62 offen offset:2048 sc1
L_h1_s2:
  v_cmp_ne_u32 vcc, s11, v51
  s_cbranch_vccz L_h1_s3
  buffer_load_dwordx4 v[48:51], v6, s[44:47], s62 offen offset:3072 sc1
L_h1_s3:
  v_cmp_ne_u32 vcc, s11, v55
  s_cbranch_vccz L_h1_s4
  buffer_load_dwordx4 v[52:55], v6, s[44:47], s63 offen offset:0 sc1
L_h1_s4:
  v_cmp_ne_u32 vcc, s11, v59
  s_cbranch_vccz L_h1_s5
  buffer_load_dwordx4 v[56:59], v6, s[44:47], s63 offen offset:1024 sc1
L_h1_s5:
  v_cmp_ne_u32 vcc, s11, v63
  s_cbranch_vccz L_h1_s6
  buffer_load_dwordx4 v[60:63], v6, s[44:47], s63 offen offset:2048 sc1
L_h1_s6:
  v_cmp_ne_u32 vcc, s11, v67
  s_cbranch_vccz L_h1_s7
  buffer_load_dwordx4 v[64:67], v6, s[44:47], s63 offen offset:3072 sc1
L_h1_s7:
L_h1_w:
  s_waitcnt vmcnt(0)
  v_xor_b32 v9, s11, v39
  v_bitop3_b32 v9, v9, v43, s11 bitop3:0xf6
  v_bitop3_b32 v9, v9, v47, s11 bitop3:0xf6
  v_bitop3_b32 v9, v9, v51, s11 bitop3:0xf6
  v_bitop3_b32 v9, v9, v55, s11 bitop3:0xf6
  v_bitop3_b32 v9, v9, v59, s11 bitop3:0xf6
  v_bitop3_b32 v9, v9, v63, s11 bitop3:0xf6
  v_bitop3_b32 v9, v9, v67, s11 bitop3:0xf6
  v_cmp_ne_u32 vcc, 0, v9
  s_cbranch_vccz L_h1_ok
  s_sub_u32 s68, s68, 1
  s_cbranch_scc0 L_h1
L_h1_ok:
  v_add_f32 v36, v36, v40
  v_add_f32 v44, v44, v48
  v_add_f32 v52, v52, v56
  v_add_f32 v60, v60, v64
  v_add_f32 v36, v36, v44
  v_add_f32 v52, v52, v60
  v_add_f32 v36, v36, v52
  v_add_f32 v37, v37, v41
  v_add_f32 v45, v45, v49
  v_add_f32 v53, v53, v57
  v_add_f32 v61, v61, v65
  v_add_f32 v37, v37, v45
  v_add_f32 v53, v53, v61
  v_add_f32 v37, v37, v53
  v_add_f32 v38, v38, v42
  v_add_f32 v46, v46, v50
  v_add_f32 v54, v54, v58
  v_add_f32 v62, v62, v66
  v_add_f32 v38, v38, v46
  v_add_f32 v54, v54, v62
  v_add_f32 v38, v38, v54
  v_cvt_pk_bf16_f32 v36, v36, v36
  v_cvt_pk_bf16_f32 v37, v37, v37
  v_cvt_pk_bf16_f32 v38, v38, v38
  ds_write_b16 v10, v36
  ds_write_b16 v10, v37 offset:32
  ds_write_b16 v10, v38 offset:64
  v_mov_b32 v14, 163672
  s_mov_b64 exec, 1
  ds_add_u32 v14, v16
  s_mov_b64 exec, -1
L_s1_skip:
  s_cmp_lt_u32 s4, 6
  s_cbranch_scc0 L_s2_skip
  s_lshl_b32 s62, s4, 4
  v_add_u32 v10, s62, v3
  v_mul_u32_u24 v10, 384, v10
  v_add_u32 v10, 49152, v10
  v_and_b32 v11, 6, v3
  v_xor_b32 v12, v2, v11
  v_lshl_add_u32 v82, v12, 4, v10
  v_add_u32 v12, 4, v2
  v_xor_b32 v12, v12, v11
  v_lshl_add_u32 v83, v12, 4, v10
  v_lshlrev_b32 v84, 4, v2
  v_add_u32 v84, 155136, v84
  s_mov_b32 s63, 0x3dd53b95
  s_lshl_b32 s62, s4, 5
  s_add_u32 s62, s62, 156160
  v_lshl_add_u32 v140, v2, 3, s62
  v_mov_b32 v14, 163664
L_wf_4:
  ds_read_b32 v15, v14 offset:4
  s_waitcnt lgkmcnt(0)
  v_cmp_gt_u32 vcc, 2, v15
  s_cbranch_vccnz L_wf_4
  ds_read_b128 v[88:91], v82 offset:0
  ds_read_b128 v[96:99], v83 offset:0
  ds_read_b128 v[104:107], v82 offset:128
  ds_read_b128 v[112:115], v83 offset:128
  ds_read_b128 v[120:123], v82 offset:256
  ds_read_b128 v[128:131], v83 offset:256
  v_mov_b32 v14, 163664
L_wf_5:
  ds_read_b32 v15, v14 offset:8
  s_waitcnt lgkmcnt(0)
  v_cmp_gt_u32 vcc, 1, v15
  s_cbranch_vccnz L_wf_5
  ds_read_b128 v[92:95], v84 offset:0
  ds_read_b128 v[100:103], v84 offset:64
  ds_read_b128 v[108:111], v84 offset:128
  ds_read_b128 v[116:119], v84 offset:192
  ds_read_b128 v[124:127], v84 offset:256
  ds_read_b128 v[132:135], v84 offset:320
  s_waitcnt lgkmcnt(5)
  v_mfma_f32_16x16x32_bf16 v[136:139], v[88:91], v[92:95], 0
  s_waitcnt lgkmcnt(4)
  v_mfma_f32_16x16x32_bf16 v[136:139], v[96:99], v[100:103], v[136:139]
  s_waitcnt lgkmcnt(3)
  v_mfma_f32_16x16x32_bf16 v[136:139], v[104:107], v[108:111], v[136:139]
  s_waitcnt lgkmcnt(2)
  v_mfma_f32_16x16x32_bf16 v[136:139], v[112:115], v[116:119], v[136:139]
  s_waitcnt lgkmcnt(1)
  v_mfma_f32_16x16x32_bf16 v[136:139], v[120:123], v[124:127], v[136:139]
  s_waitcnt lgkmcnt(0)
  v_mfma_f32_16x16x32_bf16 v[136:139], v[128:131], v[132:135], v[136:139]
  s_nop 7
  v_mul_f32 v136, s63, v136
  v_mul_f32 v137, s63, v137
  v_mul_f32 v138, s63, v138
  v_mul_f32 v139, s63, v139
  v_cvt_pk_bf16_f32 v136, v136, v137
  v_cvt_pk_bf16_f32 v137, v138, v139
  ds_write_b64 v140, v[136:137]
  v_mov_b32 v14, 163680
  s_mov_b64 exec, 1
  ds_add_u32 v14, v16
  s_mov_b64 exec, -1
L_s2_skip:
  s_cmp_lt_u32 s4, 4
  s_cbranch_scc0 L_qk_skip
  s_cmp_eq_u32 s4, 0
  s_cbranch_scc0 L_nopub2
  v_mul_u32_u24 v10, 12, v3
  v_add_u32 v10, 156160, v10
  s_lshr_b32 s62, s8, 1
  s_lshl_b32 s62, s62, 14
  s_lshl_b32 s63, s7, 9
  s_add_u32 s62, s62, s63
  s_and_b32 s63, s8, 1
  s_lshl_b32 s63, s63, 8
  s_add_u32 s62, s62, s63
  s_add_u32 s62, s62, 524288
  v_mov_b32 v23, s11
  v_mov_b32 v14, 163664
L_wf_6:
  ds_read_b32 v15, v14 offset:16
  s_waitcnt lgkmcnt(0)
  v_cmp_gt_u32 vcc, 6, v15
  s_cbranch_vccnz L_wf_6
  ds_read_b96 v[20:22], v10
  s_mov_b64 exec, 0xffff
  s_waitcnt lgkmcnt(0)
  buffer_store_dwordx4 v[20:23], v6, s[44:47], s62 offen sc1
  s_mov_b64 exec, -1
  s_waitcnt vmcnt(0)
  v_mov_b32 v14, 163724
  s_mov_b64 exec, 1
  ds_add_u32 v14, v16
  s_mov_b64 exec, -1
L_nopub2:
  s_lshl_b32 s62, s10, 14
  s_lshl_b32 s63, s4, 12
  s_add_u32 s62, s62, s63
  s_add_u32 s62, s62, 524288
  v_lshrrev_b32 v10, 5, v1
  s_lshl_b32 s63, s4, 3
  v_add_u32 v10, s63, v10
  v_mul_u32_u24 v10, 400, v10
  v_and_b32 v11, 1, v2
  v_mul_u32_u24 v11, 192, v11
  v_mul_u32_u24 v12, 12, v3
  v_add3_u32 v82, v10, v11, v12
  v_add_u32 v82, 139776, v82
  v_and_b32 v83, 31, v1
  v_lshrrev_b32 v84, 5, v1
  s_lshl_b32 s63, s4, 5
  v_add_u32 v10, s63, v83
  v_lshrrev_b32 v12, 3, v83
  v_and_b32 v12, 1, v12
  v_mul_u32_u24 v12, 5, v12
  v_and_b32 v11, 6, v83
  v_xor_b32 v11, v11, v12
  v_mul_u32_u24 v10, 384, v10
  v_add_u32 v12, 0, v84
  v_xor_b32 v12, v12, v11
  v_lshl_add_u32 v85, v12, 4, v10
  v_add_u32 v12, 2, v84
  v_xor_b32 v12, v12, v11
  v_lshl_add_u32 v86, v12, 4, v10
  v_add_u32 v12, 4, v84
  v_xor_b32 v12, v12, v11
  v_lshl_add_u32 v87, v12, 4, v10
  v_add_u32 v12, 6, v84
  v_xor_b32 v12, v12, v11
  v_lshl_add_u32 v88, v12, 4, v10
  v_mul_u32_u24 v89, 400, v83
  v_lshl_add_u32 v89, v84, 4, v89
  v_add_u32 v89, 139776, v89
  v_and_b32 v10, 1, v83
  v_lshlrev_b32 v10, 4, v10
  v_mov_b32 v11, 0x3f80
  v_lshlrev_b32 v10, v10, v11
  v_bfe_u32 v11, v83, 2, 1
  v_cmp_eq_u32 vcc, v11, v84
  s_nop 1
  v_cndmask_b32 v10, 0, v10, vcc
  v_lshrrev_b32 v11, 2, v83
  v_and_b32 v11, 6, v11
  v_bfe_u32 v12, v83, 1, 1
  v_add_u32 v11, v11, v12
  v_cmp_eq_u32 vcc, 0, v11
  s_nop 1
  v_cndmask_b32 v108, 0, v10, vcc
  v_cmp_eq_u32 vcc, 1, v11
  s_nop 1
  v_cndmask_b32 v109, 0, v10, vcc
  v_cmp_eq_u32 vcc, 2, v11
  s_nop 1
  v_cndmask_b32 v110, 0, v10, vcc
  v_cmp_eq_u32 vcc, 3, v11
  s_nop 1
  v_cndmask_b32 v111, 0, v10, vcc
  v_cmp_eq_u32 vcc, 4, v11
  s_nop 1
  v_cndmask_b32 v112, 0, v10, vcc
  v_cmp_eq_u32 vcc, 5, v11
  s_nop 1
  v_cndmask_b32 v113, 0, v10, vcc
  v_cmp_eq_u32 vcc, 6, v11
  s_nop 1
  v_cndmask_b32 v114, 0, v10, vcc
  v_cmp_eq_u32 vcc, 7, v11
  s_nop 1
  v_cndmask_b32 v115, 0, v10, vcc
  v_mov_b32 v14, 163664
L_wf_7:
  ds_read_b32 v15, v14 offset:60
  s_waitcnt lgkmcnt(0)
  v_cmp_gt_u32 vcc, 1, v15
  s_cbranch_vccnz L_wf_7
  s_mov_b32 s68, 200000
  buffer_load_dwordx4 v[36:39], v6, s[44:47], s62 offen offset:0 sc1
  buffer_load_dwordx4 v[40:43], v6, s[44:47], s62 offen offset:1024 sc1
  buffer_load_dwordx4 v[44:47], v6, s[44:47], s62 offen offset:2048 sc1
  buffer_load_dwordx4 v[48:51], v6, s[44:47], s62 offen offset:3072 sc1
  s_branch L_h2_w
L_h2:
  v_cmp_ne_u32 vcc, s11, v39
  s_cbranch_vccz L_h2_s0
  buffer_load_dwordx4 v[36:39], v6, s[44:47], s62 offen offset:0 sc1
L_h2_s0:
  v_cmp_ne_u32 vcc, s11, v43
  s_cbranch_vccz L_h2_s1
  buffer_load_dwordx4 v[40:43], v6, s[44:47], s62 offen offset:1024 sc1
L_h2_s1:
  v_cmp_ne_u32 vcc, s11, v47
  s_cbranch_vccz L_h2_s2
  buffer_load_dwordx4 v[44:47], v6, s[44:47], s62 offen offset:2048 sc1
L_h2_s2:
  v_cmp_ne_u32 vcc, s11, v51
  s_cbranch_vccz L_h2_s3
  buffer_load_dwordx4 v[48:51], v6, s[44:47], s62 offen offset:3072 sc1
L_h2_s3:
L_h2_w:
  s_waitcnt vmcnt(0)
  v_xor_b32 v9, s11, v39
  v_bitop3_b32 v9, v9, v43, s11 bitop3:0xf6
  v_bitop3_b32 v9, v9, v47, s11 bitop3:0xf6
  v_bitop3_b32 v9, v9, v51, s11 bitop3:0xf6
  v_cmp_ne_u32 vcc, 0, v9
  s_cbranch_vccz L_h2_ok
  s_sub_u32 s68, s68, 1
  s_cbranch_scc0 L_h2
L_h2_ok:
  ds_write_b96 v82, v[36:38] offset:0
  ds_write_b96 v82, v[40:42] offset:800
  ds_write_b96 v82, v[44:46] offset:1600
  ds_write_b96 v82, v[48:50] offset:2400
  v_mov_b32 v14, 163684
  s_mov_b64 exec, 1
  ds_add_u32 v14, v16
  s_mov_b64 exec, -1
  v_mov_b32 v14, 163732
L_gl_8:
  ds_read_b32 v15, v14
  s_waitcnt lgkmcnt(0)
  v_readfirstlane_b32 s71, v15
  s_cmp_eq_u32 s71, 0
  s_cbranch_scc1 L_gl_8
  s_lshl_b32 s62, s9, 2
  s_add_u32 s63, s62, s10
  s_lshl_b32 s63, s63, 2
  s_add_u32 s63, s63, s4
  s_mul_i32 s63, s63, 3072
  s_add_u32 s60, s63, 2097152
  v_mov_b32 v14, 163664
L_wf_9:
  ds_read_b32 v15, v14 offset:20
  ds_read_b32 v13, v14 offset:24
  s_waitcnt lgkmcnt(0)
  v_cmp_gt_u32 vcc, 4, v15
  v_cmp_gt_u32 s[66:67], 2, v13
  s_or_b64 vcc, vcc, s[66:67]
  s_cbranch_scc1 L_wf_9
  ds_read_b128 v[36:39], v85 offset:0
  ds_read_b128 v[40:43], v89 offset:0
  ds_read_b128 v[44:47], v86 offset:0
  ds_read_b128 v[48:51], v89 offset:32
  ds_read_b128 v[52:55], v87 offset:0
  ds_read_b128 v[56:59], v89 offset:64
  ds_read_b128 v[60:63], v88 offset:0
  ds_read_b128 v[64:67], v89 offset:96
  ds_read_b128 v[120:123], v85 offset:128
  ds_read_b128 v[124:127], v89 offset:128
  ds_read_b128 v[128:131], v86 offset:128
  ds_read_b128 v[132:135], v89 offset:160
  s_waitcnt lgkmcnt(10)
  v_mfma_f32_32x32x16_bf16 v[92:107], v[36:39], v[40:43], 0
  ds_read_b128 v[136:139], v87 offset:128
  ds_read_b128 v[140:143], v89 offset:192
  s_waitcnt lgkmcnt(10)
  v_mfma_f32_32x32x16_bf16 v[92:107], v[44:47], v[48:51], v[92:107]
  ds_read_b128 v[36:39], v88 offset:128
  ds_read_b128 v[40:43], v89 offset:224
  s_waitcnt lgkmcnt(10)
  v_mfma_f32_32x32x16_bf16 v[92:107], v[52:55], v[56:59], v[92:107]
  ds_read_b128 v[44:47], v85 offset:256
  ds_read_b128 v[48:51], v89 offset:256
  s_waitcnt lgkmcnt(10)
  v_mfma_f32_32x32x16_bf16 v[92:107], v[60:63], v[64:67], v[92:107]
  ds_read_b128 v[52:55], v86 offset:256
  ds_read_b128 v[56:59], v89 offset:288
  s_waitcnt lgkmcnt(10)
  v_mfma_f32_32x32x16_bf16 v[92:107], v[120:123], v[124:127], v[92:107]
  ds_read_b128 v[60:63], v87 offset:256
  ds_read_b128 v[64:67], v89 offset:320
  s_waitcnt lgkmcnt(10)
  v_mfma_f32_32x32x16_bf16 v[92:107], v[128:131], v[132:135], v[92:107]
  ds_read_b128 v[120:123], v88 offset:256
  ds_read_b128 v[124:127], v89 offset:352
  s_waitcnt lgkmcnt(10)
  v_mfma_f32_32x32x16_bf16 v[92:107], v[136:139], v[140:143], v[92:107]
  s_waitcnt lgkmcnt(8)
  v_mfma_f32_32x32x16_bf16 v[92:107], v[36:39], v[40:43], v[92:107]
  s_waitcnt lgkmcnt(6)
  v_mfma_f32_32x32x16_bf16 v[92:107], v[44:47], v[48:51], v[92:107]
  s_waitcnt lgkmcnt(4)
  v_mfma_f32_32x32x16_bf16 v[92:107], v[52:55], v[56:59], v[92:107]
  s_waitcnt lgkmcnt(2)
  v_mfma_f32_32x32x16_bf16 v[92:107], v[60:63], v[64:67], v[92:107]
  s_waitcnt lgkmcnt(0)
  v_mfma_f32_32x32x16_bf16 v[92:107], v[120:123], v[124:127], v[92:107]
  v_mov_b32 v123, s11
  v_mov_b32 v127, s11
  v_mov_b32 v131, s11
  v_mov_b32 v130, 0
  s_add_u32 s63, s10, 1
  s_and_b32 s63, s63, 3
  s_add_u32 s63, s63, s62
  s_lshl_b32 s63, s63, 2
  s_add_u32 s63, s63, s4
  s_mul_i32 s63, s63, 3072
  s_add_u32 s63, s63, 2097152
  s_add_u32 s64, s10, 2
  s_and_b32 s64, s64, 3
  s_add_u32 s64, s64, s62
  s_lshl_b32 s64, s64, 2
  s_add_u32 s64, s64, s4
  s_mul_i32 s64, s64, 3072
  s_add_u32 s64, s64, 2097152
  s_add_u32 s65, s10, 3
  s_and_b32 s65, s65, 3
  s_add_u32 s65, s65, s62
  s_lshl_b32 s65, s65, 2
  s_add_u32 s65, s65, s4
  s_mul_i32 s65, s65, 3072
  s_add_u32 s65, s65, 2097152
  v_cvt_pk_bf16_f32 v120, v92, v93
  v_cvt_pk_bf16_f32 v121, v94, v95
  v_cvt_pk_bf16_f32 v122, v96, v97
  v_cvt_pk_bf16_f32 v128, v98, v99
  v_cvt_pk_bf16_f32 v124, v100, v101
  v_cvt_pk_bf16_f32 v125, v102, v103
  v_cvt_pk_bf16_f32 v126, v104, v105
  v_cvt_pk_bf16_f32 v129, v106, v107
  s_cmp_eq_u32 s71, 1
  s_cbranch_scc1 L_ls_10_pl
  buffer_store_dwordx4 v[120:123], v6, s[44:47], s60 offen offset:0 sc1
  buffer_store_dwordx4 v[124:127], v6, s[44:47], s60 offen offset:1024 sc1
  buffer_store_dwordx4 v[128:131], v6, s[44:47], s60 offen offset:2048 sc1
  s_branch L_ls_10_e
L_ls_10_pl:
  buffer_store_dwordx4 v[120:123], v6, s[44:47], s60 offen offset:0
  buffer_store_dwordx4 v[124:127], v6, s[44:47], s60 offen offset:1024
  buffer_store_dwordx4 v[128:131], v6, s[44:47], s60 offen offset:2048
L_ls_10_e:
  v_mul_u32_u24 v10, 272, v83
  s_lshl_b32 s62, s4, 6
  s_add_u32 s62, s62, 154112
  v_lshl_add_u32 v11, v84, 4, s62
  v_add_u32 v140, v10, v11
  s_lshl_b32 s62, s4, 7
  s_add_u32 s62, s62, 162816
  v_lshl_add_u32 v141, v83, 2, s62
  s_waitcnt vmcnt(0)
  s_mov_b32 s68, 200000
  buffer_load_dwordx4 v[36:39], v6, s[44:47], s63 offen offset:0 sc1
  buffer_load_dwordx4 v[40:43], v6, s[44:47], s63 offen offset:1024 sc1
  buffer_load_dwordx4 v[44:47], v6, s[44:47], s63 offen offset:2048 sc1
  buffer_load_dwordx4 v[48:51], v6, s[44:47], s64 offen offset:0 sc1
  buffer_load_dwordx4 v[52:55], v6, s[44:47], s64 offen offset:1024 sc1
  buffer_load_dwordx4 v[56:59], v6, s[44:47], s64 offen offset:2048 sc1
  buffer_load_dwordx4 v[60:63], v6, s[44:47], s65 offen offset:0 sc1
  buffer_load_dwordx4 v[64:67], v6, s[44:47], s65 offen offset:1024 sc1
  buffer_load_dwordx4 v[68:71], v6, s[44:47], s65 offen offset:2048 sc1
  s_branch L_h3_w
L_h3:
  v_cmp_ne_u32 vcc, s11, v39
  s_cbranch_vccz L_h3_s0
  buffer_load_dwordx4 v[36:39], v6, s[44:47], s63 offen offset:0 sc1
L_h3_s0:
  v_cmp_ne_u32 vcc, s11, v43
  s_cbranch_vccz L_h3_s1
  buffer_load_dwordx4 v[40:43], v6, s[44:47], s63 offen offset:1024 sc1
L_h3_s1:
  v_cmp_ne_u32 vcc, s11, v47
  s_cbranch_vccz L_h3_s2
  buffer_load_dwordx4 v[44:47], v6, s[44:47], s63 offen offset:2048 sc1
L_h3_s2:
  v_cmp_ne_u32 vcc, s11, v51
  s_cbranch_vccz L_h3_s3
  buffer_load_dwordx4 v[48:51], v6, s[44:47], s64 offen offset:0 sc1
L_h3_s3:
  v_cmp_ne_u32 vcc, s11, v55
  s_cbranch_vccz L_h3_s4
  buffer_load_dwordx4 v[52:55], v6, s[44:47], s64 offen offset:1024 sc1
L_h3_s4:
  v_cmp_ne_u32 vcc, s11, v59
  s_cbranch_vccz L_h3_s5
  buffer_load_dwordx4 v[56:59], v6, s[44:47], s64 offen offset:2048 sc1
L_h3_s5:
  v_cmp_ne_u32 vcc, s11, v63
  s_cbranch_vccz L_h3_s6
  buffer_load_dwordx4 v[60:63], v6, s[44:47], s65 offen offset:0 sc1
L_h3_s6:
  v_cmp_ne_u32 vcc, s11, v67
  s_cbranch_vccz L_h3_s7
  buffer_load_dwordx4 v[64:67], v6, s[44:47], s65 offen offset:1024 sc1
L_h3_s7:
  v_cmp_ne_u32 vcc, s11, v71
  s_cbranch_vccz L_h3_s8
  buffer_load_dwordx4 v[68:71], v6, s[44:47], s65 offen offset:2048 sc1
L_h3_s8:
L_h3_w:
  s_waitcnt vmcnt(0)
  v_xor_b32 v9, s11, v39
  v_bitop3_b32 v9, v9, v43, s11 bitop3:0xf6
  v_bitop3_b32 v9, v9, v47, s11 bitop3:0xf6
  v_bitop3_b32 v9, v9, v51, s11 bitop3:0xf6
  v_bitop3_b32 v9, v9, v55, s11 bitop3:0xf6
  v_bitop3_b32 v9, v9, v59, s11 bitop3:0xf6
  v_bitop3_b32 v9, v9, v63, s11 bitop3:0xf6
  v_bitop3_b32 v9, v9, v67, s11 bitop3:0xf6
  v_bitop3_b32 v9, v9, v71, s11 bitop3:0xf6
  v_cmp_ne_u32 vcc, 0, v9
  s_cbranch_vccz L_h3_ok
  s_sub_u32 s68, s68, 1
  s_cbranch_scc0 L_h3
L_h3_ok:
  v_mov_b32 v39, v44
  v_mov_b32 v43, v45
  v_mov_b32 v51, v56
  v_mov_b32 v55, v57
  v_mov_b32 v63, v68
  v_mov_b32 v67, v69
  s_nop 1
  v_mfma_f32_32x32x16_bf16 v[92:107], v[108:111], v[36:39], v[92:107]
  v_mfma_f32_32x32x16_bf16 v[92:107], v[112:115], v[40:43], v[92:107]
  v_mfma_f32_32x32x16_bf16 v[92:107], v[108:111], v[48:51], v[92:107]
  v_mfma_f32_32x32x16_bf16 v[92:107], v[112:115], v[52:55], v[92:107]
  v_mfma_f32_32x32x16_bf16 v[92:107], v[108:111], v[60:63], v[92:107]
  v_mfma_f32_32x32x16_bf16 v[92:107], v[112:115], v[64:67], v[92:107]
  s_nop 7
  s_nop 3
  v_max3_f32 v116, v92, v93, v94
  v_max3_f32 v116, v116, v95, v96
  v_max3_f32 v116, v116, v97, v98
  v_max3_f32 v116, v116, v99, v100
  v_max3_f32 v116, v116, v101, v102
  v_max3_f32 v116, v116, v103, v104
  v_max3_f32 v116, v116, v105, v106
  v_max_f32 v116, v116, v107
  v_mov_b32 v12, v116
  s_nop 1
  v_permlane32_swap_b32 v116, v12
  s_nop 1
  v_max_f32 v116, v116, v12
  v_ceil_f32 v116, v116
  v_sub_f32 v92, v92, v116
  v_sub_f32 v93, v93, v116
  v_sub_f32 v94, v94, v116
  v_sub_f32 v95, v95, v116
  v_sub_f32 v96, v96, v116
  v_sub_f32 v97, v97, v116
  v_sub_f32 v98, v98, v116
  v_sub_f32 v99, v99, v116
  v_sub_f32 v100, v100, v116
  v_sub_f32 v101, v101, v116
  v_sub_f32 v102, v102, v116
  v_sub_f32 v103, v103, v116
  v_sub_f32 v104, v104, v116
  v_sub_f32 v105, v105, v116
  v_sub_f32 v106, v106, v116
  v_sub_f32 v107, v107, v116
  v_exp_f32 v92, v92
  v_exp_f32 v93, v93
  v_exp_f32 v94, v94
  v_exp_f32 v95, v95
  v_exp_f32 v96, v96
  v_exp_f32 v97, v97
  v_exp_f32 v98, v98
  v_exp_f32 v99, v99
  v_exp_f32 v100, v100
  v_exp_f32 v101, v101
  v_exp_f32 v102, v102
  v_exp_f32 v103, v103
  v_exp_f32 v104, v104
  v_exp_f32 v105, v105
  v_exp_f32 v106, v106
  v_exp_f32 v107, v107
  s_nop 0
  v_cvt_pk_bf16_f32 v132, v92, v93
  v_cvt_pk_bf16_f32 v133, v94, v95
  v_cvt_pk_bf16_f32 v134, v96, v97
  v_cvt_pk_bf16_f32 v135, v98, v99
  v_cvt_pk_bf16_f32 v136, v100, v101
  v_cvt_pk_bf16_f32 v137, v102, v103
  v_cvt_pk_bf16_f32 v138, v104, v105
  v_cvt_pk_bf16_f32 v139, v106, v107
  ds_write_b128 v140, v[132:135]
  ds_write_b128 v140, v[136:139] offset:32
  ds_write_b32 v141, v116
  v_mov_b32 v14, 163692
  s_mov_b64 exec, 1
  ds_add_u32 v14, v16
  s_mov_b64 exec, -1
L_qk_skip:
  s_lshr_b32 s60, s4, 2
  s_and_b32 s61, s4, 3
  s_lshl_b32 s62, s60, 4
  v_add_u32 v152, s62, v3
  v_lshlrev_b32 v154, 2, v152
  v_add_u32 v154, 162816, v154
  v_mul_u32_u24 v153, 272, v152
  v_lshl_add_u32 v153, v2, 4, v153
  v_add_u32 v153, 154112, v153
  v_and_b32 v11, 6, v7
  v_mul_u32_u24 v10, 384, v7
  s_mul_i32 s62, s61, 96
  v_mul_u32_u24 v12, 24, v5
  v_add_u32 v12, s62, v12
  v_add_u32 v13, 0, v12
  v_lshrrev_b32 v9, 4, v13
  v_xor_b32 v9, v9, v11
  v_and_b32 v13, 8, v13
  v_lshl_add_u32 v13, v9, 4, v13
  v_add_u32 v82, v13, v10
  v_add_u32 v13, 0, v12
  v_lshrrev_b32 v9, 4, v13
  v_xor_b32 v9, v9, v11
  v_xor_b32 v9, 5, v9
  v_and_b32 v13, 8, v13
  v_lshl_add_u32 v13, v9, 4, v13
  v_add_u32 v83, v13, v10
  v_add_u32 v13, 8, v12
  v_lshrrev_b32 v9, 4, v13
  v_xor_b32 v9, v9, v11
  v_and_b32 v13, 8, v13
  v_lshl_add_u32 v13, v9, 4, v13
  v_add_u32 v84, v13, v10
  v_add_u32 v13, 8, v12
  v_lshrrev_b32 v9, 4, v13
  v_xor_b32 v9, v9, v11
  v_xor_b32 v9, 5, v9
  v_and_b32 v13, 8, v13
  v_lshl_add_u32 v13, v9, 4, v13
  v_add_u32 v85, v13, v10
  v_add_u32 v13, 16, v12
  v_lshrrev_b32 v9, 4, v13
  v_xor_b32 v9, v9, v11
  v_and_b32 v13, 8, v13
  v_lshl_add_u32 v13, v9, 4, v13
  v_add_u32 v86, v13, v10
  v_add_u32 v13, 16, v12
  v_lshrrev_b32 v9, 4, v13
  v_xor_b32 v9, v9, v11
  v_xor_b32 v9, 5, v9
  v_and_b32 v13, 8, v13
  v_lshl_add_u32 v13, v9, 4, v13
  v_add_u32 v87, v13, v10
  s_lshl_b32 s62, s9, 2
  s_add_u32 s62, s62, s10
  s_lshl_b32 s62, s62, 3
  s_add_u32 s62, s62, s4
  s_lshl_b32 s62, s62, 11
  s_add_u32 s64, s62, 6291456
  v_mov_b32 v14, 163664
L_wf_11:
  ds_read_b32 v15, v14 offset:24
  s_waitcnt lgkmcnt(0)
  v_cmp_gt_u32 vcc, 2, v15
  s_cbranch_vccnz L_wf_11
  ds_read_b64_tr_b16 v[112:113], v82 offset:0
  ds_read_b64_tr_b16 v[114:115], v83 offset:3072
  ds_read_b64_tr_b16 v[116:117], v84 offset:0
  ds_read_b64_tr_b16 v[118:119], v85 offset:3072
  ds_read_b64_tr_b16 v[120:121], v86 offset:0
  ds_read_b64_tr_b16 v[122:123], v87 offset:3072
  ds_read_b64_tr_b16 v[124:125], v82 offset:12288
  ds_read_b64_tr_b16 v[126:127], v83 offset:15360
  ds_read_b64_tr_b16 v[128:129], v84 offset:12288
  ds_read_b64_tr_b16 v[130:131], v85 offset:15360
  ds_read_b64_tr_b16 v[132:133], v86 offset:12288
  ds_read_b64_tr_b16 v[134:135], v87 offset:15360
  v_mov_b32 v14, 163664
L_wf_12:
  ds_read_b32 v15, v14 offset:28
  s_waitcnt lgkmcnt(0)
  v_cmp_gt_u32 vcc, 4, v15
  s_cbranch_vccnz L_wf_12
  ds_read_b32 v104, v154
  ds_read_b32 v105, v154 offset:128
  ds_read_b32 v106, v154 offset:256
  ds_read_b32 v107, v154 offset:384
  ds_read_b128 v[88:91], v153
  ds_read_b128 v[92:95], v153 offset:64
  ds_read_b128 v[96:99], v153 offset:128
  ds_read_b128 v[100:103], v153 offset:192
  ds_read_b64_tr_b16 v[136:137], v82 offset:24576
  ds_read_b64_tr_b16 v[138:139], v83 offset:27648
  ds_read_b64_tr_b16 v[140:141], v84 offset:24576
  ds_read_b64_tr_b16 v[142:143], v85 offset:27648
  ds_read_b64_tr_b16 v[144:145], v86 offset:24576
  ds_read_b64_tr_b16 v[146:147], v87 offset:27648
  s_waitcnt lgkmcnt(10)
  v_max3_f32 v10, v104, v105, v106
  v_max_f32 v10, v10, v107
  v_sub_f32 v11, v10, v104
  v_cvt_u32_f32 v11, v11
  v_min_u32 v11, 255, v11
  v_lshlrev_b32 v12, 7, v11
  v_lshl_or_b32 v108, v11, 23, v12
  v_sub_f32 v11, v10, v105
  v_cvt_u32_f32 v11, v11
  v_min_u32 v11, 255, v11
  v_lshlrev_b32 v12, 7, v11
  v_lshl_or_b32 v109, v11, 23, v12
  v_sub_f32 v11, v10, v106
  v_cvt_u32_f32 v11, v11
  v_min_u32 v11, 255, v11
  v_lshlrev_b32 v12, 7, v11
  v_lshl_or_b32 v110, v11, 23, v12
  v_sub_f32 v11, v10, v107
  v_cvt_u32_f32 v11, v11
  v_min_u32 v11, 255, v11
  v_lshlrev_b32 v12, 7, v11
  v_lshl_or_b32 v111, v11, 23, v12
  v_mov_b32 v104, v10
  s_waitcnt lgkmcnt(9)
  v_pk_sub_u16 v88, v88, v108 clamp
  v_pk_sub_u16 v89, v89, v108 clamp
  v_pk_sub_u16 v90, v90, v108 clamp
  v_pk_sub_u16 v91, v91, v108 clamp
  s_waitcnt lgkmcnt(8)
  v_pk_sub_u16 v92, v92, v109 clamp
  v_pk_sub_u16 v93, v93, v109 clamp
  v_pk_sub_u16 v94, v94, v109 clamp
  v_pk_sub_u16 v95, v95, v109 clamp
  s_waitcnt lgkmcnt(7)
  v_pk_sub_u16 v96, v96, v110 clamp
  v_pk_sub_u16 v97, v97, v110 clamp
  v_pk_sub_u16 v98, v98, v110 clamp
  v_pk_sub_u16 v99, v99, v110 clamp
  s_waitcnt lgkmcnt(6)
  v_pk_sub_u16 v100, v100, v111 clamp
  v_pk_sub_u16 v101, v101, v111 clamp
  v_pk_sub_u16 v102, v102, v111 clamp
  v_pk_sub_u16 v103, v103, v111 clamp
  s_nop 1
  v_mfma_f32_16x16x32_bf16 v[24:27], v[112:115], v[88:91], 0
  v_mfma_f32_16x16x32_bf16 v[28:31], v[116:119], v[88:91], 0
  v_mfma_f32_16x16x32_bf16 v[32:35], v[120:123], v[88:91], 0
  ds_read_b64_tr_b16 v[112:113], v82 offset:36864
  ds_read_b64_tr_b16 v[114:115], v83 offset:39936
  ds_read_b64_tr_b16 v[116:117], v84 offset:36864
  ds_read_b64_tr_b16 v[118:119], v85 offset:39936
  ds_read_b64_tr_b16 v[120:121], v86 offset:36864
  ds_read_b64_tr_b16 v[122:123], v87 offset:39936
  v_mfma_f32_16x16x32_bf16 v[24:27], v[124:127], v[92:95], v[24:27]
  v_mfma_f32_16x16x32_bf16 v[28:31], v[128:131], v[92:95], v[28:31]
  v_mfma_f32_16x16x32_bf16 v[32:35], v[132:135], v[92:95], v[32:35]
  s_waitcnt lgkmcnt(6)
  v_mfma_f32_16x16x32_bf16 v[24:27], v[136:139], v[96:99], v[24:27]
  v_mfma_f32_16x16x32_bf16 v[28:31], v[140:143], v[96:99], v[28:31]
  v_mfma_f32_16x16x32_bf16 v[32:35], v[144:147], v[96:99], v[32:35]
  s_waitcnt lgkmcnt(0)
  v_mfma_f32_16x16x32_bf16 v[24:27], v[112:115], v[100:103], v[24:27]
  v_mfma_f32_16x16x32_bf16 v[28:31], v[116:119], v[100:103], v[28:31]
  v_mfma_f32_16x16x32_bf16 v[32:35], v[120:123], v[100:103], v[32:35]
  v_and_b32 v10, 7, v3
  v_lshlrev_b32 v10, 7, v10
  v_lshl_add_u32 v10, v2, 5, v10
  v_lshrrev_b32 v11, 3, v3
  v_lshl_add_u32 v10, v11, 4, v10
  v_mov_b32 v39, s11
  v_mov_b32 v43, s11
  s_nop 3
  v_cvt_pk_bf16_f32 v36, v24, v25
  v_cvt_pk_bf16_f32 v37, v26, v27
  v_cvt_pk_bf16_f32 v38, v28, v29
  v_cvt_pk_bf16_f32 v40, v30, v31
  v_cvt_pk_bf16_f32 v41, v32, v33
  v_cvt_pk_bf16_f32 v42, v34, v35
  v_mov_b32 v44, v36
  v_mov_b32 v45, v37
  v_mov_b32 v46, v38
  s_nop 1
  v_mov_b32_dpp v36, v40 row_ror:8 row_mask:0xf bank_mask:0xc
  v_mov_b32_dpp v37, v41 row_ror:8 row_mask:0xf bank_mask:0xc
  v_mov_b32_dpp v38, v42 row_ror:8 row_mask:0xf bank_mask:0xc
  v_mov_b32_dpp v40, v44 row_ror:8 row_mask:0xf bank_mask:0x3
  v_mov_b32_dpp v41, v45 row_ror:8 row_mask:0xf bank_mask:0x3
  v_mov_b32_dpp v42, v46 row_ror:8 row_mask:0xf bank_mask:0x3
  s_cmp_lt_u32 s4, 5
  s_cbranch_scc0 L_np4
L_np4:
  buffer_store_dwordx4 v[36:39], v10, s[44:47], s64 offen sc1
  buffer_store_dwordx4 v[40:43], v10, s[44:47], s64 offen offset:1024 sc1
  s_cmp_eq_u32 s61, 0
  s_cbranch_scc0 L_noml
  v_mov_b32 v48, 0x3f803f80
  v_mov_b32 v49, 0x3f803f80
  v_mov_b32 v50, 0x3f803f80
  v_mov_b32 v51, 0x3f803f80
  s_nop 1
  v_mfma_f32_16x16x32_bf16 v[148:151], v[48:51], v[88:91], 0
  v_mfma_f32_16x16x32_bf16 v[148:151], v[48:51], v[92:95], v[148:151]
  v_mfma_f32_16x16x32_bf16 v[148:151], v[48:51], v[96:99], v[148:151]
  v_mfma_f32_16x16x32_bf16 v[148:151], v[48:51], v[100:103], v[148:151]
  s_nop 7
  v_mov_b32 v20, v104
  v_mov_b32 v21, v148
  v_mov_b32 v22, 0
  v_mov_b32 v23, s11
  v_lshlrev_b32 v10, 4, v152
  s_lshl_b32 s62, s9, 11
  s_lshl_b32 s63, s10, 9
  s_add_u32 s62, s62, s63
  s_add_u32 s62, s62, 1572864
  s_mov_b64 exec, 0xffff
  buffer_store_dwordx4 v[20:23], v10, s[44:47], s62 offen sc1
  s_mov_b64 exec, -1
L_noml:
  s_cmp_lt_u32 s4, 6
  s_cbranch_scc0 L_fin
  s_cmp_lt_u32 s4, 4
  s_cbranch_scc0 L_h4_notA
  s_lshl_b32 s62, s4, 20
  s_lshr_b32 s63, s8, 1
  s_lshl_b32 s63, s63, 14
  s_add_u32 s62, s62, s63
  s_lshr_b32 s63, s7, 4
  s_lshl_b32 s63, s63, 13
  s_add_u32 s62, s62, s63
  s_and_b32 s63, s8, 1
  s_lshl_b32 s63, s63, 12
  s_add_u32 s62, s62, s63
  s_and_b32 s63, s7, 15
  s_lshl_b32 s63, s63, 7
  s_add_u32 s62, s62, s63
  s_add_u32 s62, s62, 6291456
  s_add_u32 s63, s62, 262144
  s_add_u32 s64, s62, 524288
  s_add_u32 s65, s62, 786432
  v_lshlrev_b32 v83, 16, v2
  v_bfe_u32 v10, v1, 3, 1
  v_lshl_add_u32 v83, v10, 11, v83
  v_and_b32 v10, 7, v1
  v_lshl_add_u32 v83, v10, 4, v83
  s_lshl_b32 s66, s4, 4
  v_add_u32 v10, s66, v2
  v_mul_u32_u24 v10, 224, v10
  v_mul_u32_u24 v11, 12, v3
  v_add_u32 v82, v10, v11
  v_add_u32 v82, 139776, v82
  s_nop 0
  s_waitcnt vmcnt(0)
  s_mov_b32 s68, 200000
  buffer_load_dwordx4 v[44:47], v83, s[44:47], s62 offen sc1
  buffer_load_dwordx4 v[48:51], v83, s[44:47], s63 offen sc1
  buffer_load_dwordx4 v[52:55], v83, s[44:47], s64 offen sc1
  buffer_load_dwordx4 v[56:59], v83, s[44:47], s65 offen sc1
  s_branch L_h4_w
L_h4:
  v_cmp_ne_u32 vcc, s11, v47
  s_cbranch_vccz L_h4_s0
  buffer_load_dwordx4 v[44:47], v83, s[44:47], s62 offen sc1
L_h4_s0:
  v_cmp_ne_u32 vcc, s11, v51
  s_cbranch_vccz L_h4_s1
  buffer_load_dwordx4 v[48:51], v83, s[44:47], s63 offen sc1
L_h4_s1:
  v_cmp_ne_u32 vcc, s11, v55
  s_cbranch_vccz L_h4_s2
  buffer_load_dwordx4 v[52:55], v83, s[44:47], s64 offen sc1
L_h4_s2:
  v_cmp_ne_u32 vcc, s11, v59
  s_cbranch_vccz L_h4_s3
  buffer_load_dwordx4 v[56:59], v83, s[44:47], s65 offen sc1
L_h4_s3:
L_h4_w:
  s_waitcnt vmcnt(0)
  v_xor_b32 v9, s11, v47
  v_bitop3_b32 v9, v9, v51, s11 bitop3:0xf6
  v_bitop3_b32 v9, v9, v55, s11 bitop3:0xf6
  v_bitop3_b32 v9, v9, v59, s11 bitop3:0xf6
  v_cmp_ne_u32 vcc, 0, v9
  s_cbranch_vccz L_h4_ok
  s_sub_u32 s68, s68, 1
  s_cbranch_scc0 L_h4
L_h4_ok:
  ds_write_b96 v82, v[44:46] offset:0
  ds_write_b96 v82, v[48:50] offset:896
  ds_write_b96 v82, v[52:54] offset:1792
  ds_write_b96 v82, v[56:58] offset:2688
  v_mov_b32 v14, 163696
  s_mov_b64 exec, 1
  ds_add_u32 v14, v16
  s_mov_b64 exec, -1
  s_branch L_h4_end
L_h4_notA:
  s_cmp_eq_u32 s4, 4
  s_cbranch_scc0 L_h4_end
  s_lshl_b32 s62, s7, 4
  s_lshr_b32 s63, s8, 1
  s_lshl_b32 s63, s63, 9
  s_add_u32 s62, s62, s63
  s_add_u32 s62, s62, 1572864
  v_lshlrev_b32 v48, 11, v1
  v_mov_b32 v11, 163328
  ds_read_b32 v82, v11
  v_and_b32 v9, 0xfffffff3, v1
  v_bfe_u32 v11, v1, 2, 1
  v_lshl_or_b32 v9, v11, 3, v9
  v_bfe_u32 v11, v1, 3, 1
  v_lshl_or_b32 v9, v11, 2, v9
  v_lshlrev_b32 v9, 1, v9
  v_add_u32 v49, 163344, v9
  s_waitcnt vmcnt(0)
  s_mov_b32 s68, 200000
  buffer_load_dwordx4 v[44:47], v48, s[44:47], s62 offen sc1
  s_branch L_ml_w
L_ml:
  v_cmp_ne_u32 vcc, s11, v47
  buffer_load_dwordx4 v[44:47], v48, s[44:47], s62 offen sc1
L_ml_w:
  s_waitcnt vmcnt(0)
  v_xor_b32 v9, s11, v47
  v_cmp_ne_u32 vcc, 0, v9
  s_cbranch_vccz L_ml_ok
  s_sub_u32 s68, s68, 1
  s_cbranch_scc0 L_ml
L_ml_ok:
  v_mov_b32 v10, v44
  s_nop 1
  v_max_f32_dpp v10, v10, v10 row_ror:8 row_mask:0xf bank_mask:0xf
  s_nop 1
  v_max_f32_dpp v10, v10, v10 row_ror:4 row_mask:0xf bank_mask:0xf
  s_nop 1
  v_max_f32_dpp v10, v10, v10 row_ror:2 row_mask:0xf bank_mask:0xf
  s_nop 1
  v_max_f32_dpp v10, v10, v10 row_ror:1 row_mask:0xf bank_mask:0xf
  v_mov_b32 v11, v10
  s_nop 1
  v_permlane16_swap_b32 v10, v11
  s_nop 1
  v_max_f32 v10, v10, v11
  v_mov_b32 v11, v10
  s_nop 1
  v_permlane32_swap_b32 v10, v11
  s_nop 1
  v_max_f32 v10, v10, v11
  v_sub_f32 v12, v44, v10
  v_exp_f32 v12, v12
  s_nop 0
  v_cvt_pk_bf16_f32 v13, v12, v12
  ds_write_b16 v49, v13
  v_mov_b32 v14, 163700
  s_mov_b64 exec, 1
  ds_add_u32 v14, v16
  s_mov_b64 exec, -1
  v_mul_f32 v13, v12, v45
  s_nop 1
  v_add_f32_dpp v13, v13, v13 row_ror:8 row_mask:0xf bank_mask:0xf
  s_nop 1
  v_add_f32_dpp v13, v13, v13 row_ror:4 row_mask:0xf bank_mask:0xf
  s_nop 1
  v_add_f32_dpp v13, v13, v13 row_ror:2 row_mask:0xf bank_mask:0xf
  s_nop 1
  v_add_f32_dpp v13, v13, v13 row_ror:1 row_mask:0xf bank_mask:0xf
  v_mov_b32 v11, v13
  s_nop 1
  v_permlane16_swap_b32 v13, v11
  s_nop 1
  v_add_f32 v13, v13, v11
  v_mov_b32 v11, v13
  s_nop 1
  v_permlane32_swap_b32 v13, v11
  s_nop 1
  v_add_f32 v13, v13, v11
  v_rcp_f32 v13, v13
  s_waitcnt lgkmcnt(0)
  v_mul_f32 v10, v82, v13
  v_mov_b32 v11, 163332
  ds_write_b32 v11, v10
  v_mov_b32 v14, 163740
  s_mov_b64 exec, 1
  ds_add_u32 v14, v16
  s_mov_b64 exec, -1
L_h4_end:
  v_lshlrev_b32 v102, 4, v2
  v_add_u32 v102, 163344, v102
  v_mul_u32_u24 v10, 224, v7
  s_lshl_b32 s62, s4, 5
  s_add_u32 s62, s62, 139776
  v_lshl_add_u32 v11, v5, 3, s62
  v_add_u32 v100, v10, v11
  v_and_b32 v10, 0xfffffff3, v3
  v_bfe_u32 v11, v3, 2, 1
  v_lshl_or_b32 v10, v11, 3, v10
  v_bfe_u32 v11, v3, 3, 1
  v_lshl_or_b32 v10, v11, 2, v10
  s_lshl_b32 s62, s4, 5
  s_add_u32 s62, s62, 163472
  v_lshl_add_u32 v101, v10, 1, s62
  v_mov_b32 v14, 163664
L_wf_13:
  ds_read_b32 v15, v14 offset:32
  ds_read_b32 v13, v14 offset:36
  s_waitcnt lgkmcnt(0)
  v_cmp_gt_u32 vcc, 4, v15
  v_cmp_gt_u32 s[66:67], 1, v13
  s_or_b64 vcc, vcc, s[66:67]
  s_cbranch_scc1 L_wf_13
  ds_read_b128 v[84:87], v102
  ds_read_b128 v[88:91], v102 offset:64
  ds_read_b64_tr_b16 v[92:93], v100
  ds_read_b64_tr_b16 v[94:95], v100 offset:1792
  ds_read_b64_tr_b16 v[96:97], v100 offset:7168
  ds_read_b64_tr_b16 v[98:99], v100 offset:8960
  s_waitcnt lgkmcnt(2)
  v_mfma_f32_16x16x32_bf16 v[104:107], v[84:87], v[92:95], 0
  s_waitcnt lgkmcnt(0)
  v_mfma_f32_16x16x32_bf16 v[104:107], v[88:91], v[96:99], v[104:107]
  s_nop 7
  v_cvt_pk_bf16_f32 v104, v104, v104
  ds_write_b16 v101, v104
  v_mov_b32 v14, 163704
  s_mov_b64 exec, 1
  ds_add_u32 v14, v16
  s_mov_b64 exec, -1
  s_lshl_b32 s62, s7, 3
  s_add_u32 s62, s62, s8
  s_mul_i32 s62, s62, 1536
  s_add_u32 s60, s62, 1048576
  s_cmp_lt_u32 s4, 4
  s_cbranch_scc0 L_b1
  v_and_b32 v11, 6, v7
  v_mul_u32_u24 v10, 384, v7
  v_and_b32 v12, 1, v5
  v_lshl_add_u32 v10, v12, 3, v10
  v_add_u32 v10, 49152, v10
  v_lshrrev_b32 v12, 1, v5
  s_mul_i32 s62, s4, 6
  s_add_u32 s63, s62, 0
  v_add_u32 v13, s63, v12
  v_xor_b32 v13, v13, v11
  v_lshl_add_u32 v82, v13, 4, v10
  s_add_u32 s63, s62, 2
  v_add_u32 v13, s63, v12
  v_xor_b32 v13, v13, v11
  v_lshl_add_u32 v83, v13, 4, v10
  s_add_u32 s63, s62, 4
  v_add_u32 v13, s63, v12
  v_xor_b32 v13, v13, v11
  v_lshl_add_u32 v84, v13, 4, v10
  v_lshlrev_b32 v136, 4, v2
  v_add_u32 v136, 163472, v136
  s_lshl_b32 s63, s4, 8
  s_add_u32 s64, s60, s63
  v_mov_b32 v14, 163664
L_wf_14:
  ds_read_b32 v15, v14 offset:44
  s_waitcnt lgkmcnt(0)
  v_cmp_gt_u32 vcc, 2, v15
  s_cbranch_vccnz L_wf_14
  ds_read_b64_tr_b16 v[100:101], v82 offset:0
  ds_read_b64_tr_b16 v[102:103], v82 offset:3072
  ds_read_b64_tr_b16 v[104:105], v83 offset:0
  ds_read_b64_tr_b16 v[106:107], v83 offset:3072
  ds_read_b64_tr_b16 v[108:109], v84 offset:0
  ds_read_b64_tr_b16 v[110:111], v84 offset:3072
  ds_read_b64_tr_b16 v[112:113], v82 offset:12288
  ds_read_b64_tr_b16 v[114:115], v82 offset:15360
  ds_read_b64_tr_b16 v[116:117], v83 offset:12288
  ds_read_b64_tr_b16 v[118:119], v83 offset:15360
  ds_read_b64_tr_b16 v[120:121], v84 offset:12288
  ds_read_b64_tr_b16 v[122:123], v84 offset:15360
  v_mov_b32 v14, 163664
L_wf_15:
  ds_read_b32 v15, v14 offset:40
  ds_read_b32 v13, v14 offset:76
  s_waitcnt lgkmcnt(0)
  v_cmp_gt_u32 vcc, 6, v15
  v_cmp_gt_u32 s[66:67], 1, v13
  s_or_b64 vcc, vcc, s[66:67]
  s_cbranch_scc1 L_wf_15
  v_mov_b32 v11, 163332
  ds_read_b32 v137, v11
  ds_read_b128 v[88:91], v136
  ds_read_b128 v[92:95], v136 offset:64
  ds_read_b128 v[96:99], v136 offset:128
  ds_read_b64_tr_b16 v[124:125], v82 offset:24576
  ds_read_b64_tr_b16 v[126:127], v82 offset:27648
  ds_read_b64_tr_b16 v[128:129], v83 offset:24576
  ds_read_b64_tr_b16 v[130:131], v83 offset:27648
  ds_read_b64_tr_b16 v[132:133], v84 offset:24576
  ds_read_b64_tr_b16 v[134:135], v84 offset:27648
  s_waitcnt lgkmcnt(8)
  v_mfma_f32_16x16x32_bf16 v[24:27], v[88:91], v[100:103], 0
  v_mfma_f32_16x16x32_bf16 v[28:31], v[88:91], v[104:107], 0
  v_mfma_f32_16x16x32_bf16 v[32:35], v[88:91], v[108:111], 0
  s_waitcnt lgkmcnt(7)
  v_mfma_f32_16x16x32_bf16 v[24:27], v[92:95], v[112:115], v[24:27]
  v_mfma_f32_16x16x32_bf16 v[28:31], v[92:95], v[116:119], v[28:31]
  v_mfma_f32_16x16x32_bf16 v[32:35], v[92:95], v[120:123], v[32:35]
  s_waitcnt lgkmcnt(0)
  v_mfma_f32_16x16x32_bf16 v[24:27], v[96:99], v[124:127], v[24:27]
  v_mfma_f32_16x16x32_bf16 v[28:31], v[96:99], v[128:131], v[28:31]
  v_mfma_f32_16x16x32_bf16 v[32:35], v[96:99], v[132:135], v[32:35]
  s_cmp_lt_u32 s4, 2
  s_cbranch_scc0 L_np5
L_np5:
  s_nop 7
  v_mul_f32 v24, v24, v137
  v_mul_f32 v28, v28, v137
  v_mul_f32 v32, v32, v137
  v_mov_b32 v23, s11

  v_mov_b32 v20, v24
  v_mov_b32 v21, v28
  v_mov_b32 v22, v32
  s_mov_b64 exec, 0xffff
  s_cmp_eq_u32 s71, 1
  s_cbranch_scc1 L_ls_16_pl
  buffer_store_dwordx4 v[20:23], v6, s[44:47], s64 offen sc1
  s_branch L_ls_16_e
L_ls_16_pl:
  buffer_store_dwordx4 v[20:23], v6, s[44:47], s64 offen
L_ls_16_e:
  s_mov_b64 exec, -1
  s_mul_i32 s62, s7, 12288
  s_add_u32 s62, s62, 1048576
  s_cmp_eq_u32 s4, 0
  s_cbranch_scc0 L_h5_w1
  s_add_u32 s63, s62, 3072
  s_add_u32 s64, s62, 6144
  s_add_u32 s65, s62, 9216
  v_and_b32 v10, 0xfffffff3, v3
  v_bfe_u32 v11, v3, 2, 1
  v_lshl_or_b32 v10, v11, 3, v10
  v_bfe_u32 v11, v3, 3, 1
  v_lshl_or_b32 v10, v11, 2, v10
  v_mul_u32_u24 v11, 48, v2
  v_add_u32 v10, v10, v11
  v_lshlrev_b32 v10, 1, v10
  v_add_u32 v138, 139776, v10
  s_waitcnt vmcnt(0)
  s_mov_b32 s68, 200000
  buffer_load_dwordx4 v[36:39], v6, s[44:47], s62 offen offset:0 sc1
  buffer_load_dwordx4 v[40:43], v6, s[44:47], s62 offen offset:1536 sc1
  buffer_load_dwordx4 v[44:47], v6, s[44:47], s63 offen offset:0 sc1
  buffer_load_dwordx4 v[48:51], v6, s[44:47], s63 offen offset:1536 sc1
  buffer_load_dwordx4 v[52:55], v6, s[44:47], s64 offen offset:0 sc1
  buffer_load_dwordx4 v[56:59], v6, s[44:47], s64 offen offset:1536 sc1
  buffer_load_dwordx4 v[60:63], v6, s[44:47], s65 offen offset:0 sc1
  buffer_load_dwordx4 v[64:67], v6, s[44:47], s65 offen offset:1536 sc1
  s_branch L_h5_w
L_h5:
  v_cmp_ne_u32 vcc, s11, v39
  s_cbranch_vccz L_h5_s0
  buffer_load_dwordx4 v[36:39], v6, s[44:47], s62 offen offset:0 sc1
L_h5_s0:
  v_cmp_ne_u32 vcc, s11, v43
  s_cbranch_vccz L_h5_s1
  buffer_load_dwordx4 v[40:43], v6, s[44:47], s62 offen offset:1536 sc1
L_h5_s1:
  v_cmp_ne_u32 vcc, s11, v47
  s_cbranch_vccz L_h5_s2
  buffer_load_dwordx4 v[44:47], v6, s[44:47], s63 offen offset:0 sc1
L_h5_s2:
  v_cmp_ne_u32 vcc, s11, v51
  s_cbranch_vccz L_h5_s3
  buffer_load_dwordx4 v[48:51], v6, s[44:47], s63 offen offset:1536 sc1
L_h5_s3:
  v_cmp_ne_u32 vcc, s11, v55
  s_cbranch_vccz L_h5_s4
  buffer_load_dwordx4 v[52:55], v6, s[44:47], s64 offen offset:0 sc1
L_h5_s4:
  v_cmp_ne_u32 vcc, s11, v59
  s_cbranch_vccz L_h5_s5
  buffer_load_dwordx4 v[56:59], v6, s[44:47], s64 offen offset:1536 sc1
L_h5_s5:
  v_cmp_ne_u32 vcc, s11, v63
  s_cbranch_vccz L_h5_s6
  buffer_load_dwordx4 v[60:63], v6, s[44:47], s65 offen offset:0 sc1
L_h5_s6:
  v_cmp_ne_u32 vcc, s11, v67
  s_cbranch_vccz L_h5_s7
  buffer_load_dwordx4 v[64:67], v6, s[44:47], s65 offen offset:1536 sc1
L_h5_s7:
L_h5_w:
  s_waitcnt vmcnt(0)
  v_xor_b32 v9, s11, v39
  v_bitop3_b32 v9, v9, v43, s11 bitop3:0xf6
  v_bitop3_b32 v9, v9, v47, s11 bitop3:0xf6
  v_bitop3_b32 v9, v9, v51, s11 bitop3:0xf6
  v_bitop3_b32 v9, v9, v55, s11 bitop3:0xf6
  v_bitop3_b32 v9, v9, v59, s11 bitop3:0xf6
  v_bitop3_b32 v9, v9, v63, s11 bitop3:0xf6
  v_bitop3_b32 v9, v9, v67, s11 bitop3:0xf6
  v_cmp_ne_u32 vcc, 0, v9
  s_cbranch_vccz L_h5_ok
  s_sub_u32 s68, s68, 1
  s_cbranch_scc0 L_h5
L_h5_ok:
  v_add_f32 v36, v36, v40
  v_add_f32 v44, v44, v48
  v_add_f32 v52, v52, v56
  v_add_f32 v60, v60, v64
  v_add_f32 v36, v36, v44
  v_add_f32 v52, v52, v60
  v_add_f32 v36, v36, v52
  v_add_f32 v37, v37, v41
  v_add_f32 v45, v45, v49
  v_add_f32 v53, v53, v57
  v_add_f32 v61, v61, v65
  v_add_f32 v37, v37, v45
  v_add_f32 v53, v53, v61
  v_add_f32 v37, v37, v53
  v_add_f32 v38, v38, v42
  v_add_f32 v46, v46, v50
  v_add_f32 v54, v54, v58
  v_add_f32 v62, v62, v66
  v_add_f32 v38, v38, v46
  v_add_f32 v54, v54, v62
  v_add_f32 v38, v38, v54
  v_cvt_pk_bf16_f32 v36, v36, v36
  v_cvt_pk_bf16_f32 v37, v37, v37
  v_cvt_pk_bf16_f32 v38, v38, v38
  ds_write_b16 v138, v36
  ds_write_b16 v138, v37 offset:32
  ds_write_b16 v138, v38 offset:64
  v_mov_b32 v14, 163712
  s_mov_b64 exec, 1
  ds_add_u32 v14, v16
  s_mov_b64 exec, -1
  s_branch L_s5
L_h5_w1:
  s_cmp_eq_u32 s4, 1
  s_cbranch_scc0 L_s5
  v_lshrrev_b32 v10, 5, v1
  v_mul_u32_u24 v10, 1536, v10
  v_and_b32 v11, 31, v1
  v_lshl_add_u32 v139, v11, 4, v10
  s_add_u32 s62, s62, 1024
  s_add_u32 s63, s62, 6144
  v_mov_b32 v11, 163328
  ds_read_b32 v138, v11
  s_waitcnt vmcnt(0)
  s_mov_b32 s68, 200000
  buffer_load_dwordx4 v[36:39], v139, s[44:47], s62 offen offset:0 sc1
  buffer_load_dwordx4 v[40:43], v139, s[44:47], s62 offen offset:3072 sc1
  buffer_load_dwordx4 v[44:47], v139, s[44:47], s63 offen offset:0 sc1
  buffer_load_dwordx4 v[48:51], v139, s[44:47], s63 offen offset:3072 sc1
  s_branch L_h5g_w
L_h5g:
  v_cmp_ne_u32 vcc, s11, v39
  s_cbranch_vccz L_h5g_s0
  buffer_load_dwordx4 v[36:39], v139, s[44:47], s62 offen offset:0 sc1
L_h5g_s0:
  v_cmp_ne_u32 vcc, s11, v43
  s_cbranch_vccz L_h5g_s1
  buffer_load_dwordx4 v[40:43], v139, s[44:47], s62 offen offset:3072 sc1
L_h5g_s1:
  v_cmp_ne_u32 vcc, s11, v47
  s_cbranch_vccz L_h5g_s2
  buffer_load_dwordx4 v[44:47], v139, s[44:47], s63 offen offset:0 sc1
L_h5g_s2:
  v_cmp_ne_u32 vcc, s11, v51
  s_cbranch_vccz L_h5g_s3
  buffer_load_dwordx4 v[48:51], v139, s[44:47], s63 offen offset:3072 sc1
L_h5g_s3:
L_h5g_w:
  s_waitcnt vmcnt(0)
  v_xor_b32 v9, s11, v39
  v_bitop3_b32 v9, v9, v43, s11 bitop3:0xf6
  v_bitop3_b32 v9, v9, v47, s11 bitop3:0xf6
  v_bitop3_b32 v9, v9, v51, s11 bitop3:0xf6
  v_cmp_ne_u32 vcc, 0, v9
  s_cbranch_vccz L_h5g_ok
  s_sub_u32 s68, s68, 1
  s_cbranch_scc0 L_h5g
L_h5g_ok:
  s_waitcnt lgkmcnt(0)
  v_add_f32 v36, v36, v40
  v_add_f32 v44, v44, v48
  v_add_f32 v36, v36, v44
  v_mov_b32 v40, v36
  v_add_f32 v37, v37, v41
  v_add_f32 v45, v45, v49
  v_add_f32 v37, v37, v45
  v_mov_b32 v41, v37
  v_add_f32 v38, v38, v42
  v_add_f32 v46, v46, v50
  v_add_f32 v38, v38, v46
  v_mov_b32 v42, v38
  s_nop 1
  v_permlane32_swap_b32 v36, v40
  v_permlane32_swap_b32 v37, v41
  v_permlane32_swap_b32 v38, v42
  s_nop 1
  v_add_f32 v36, v36, v40
  v_mov_b32 v40, v36
  v_add_f32 v37, v37, v41
  v_mov_b32 v41, v37
  v_add_f32 v38, v38, v42
  v_mov_b32 v42, v38
  s_nop 1
  v_permlane16_swap_b32 v36, v40
  v_permlane16_swap_b32 v37, v41
  v_permlane16_swap_b32 v38, v42
  s_nop 1
  v_sub_f32 v13, 1.0, v138
  v_mul_f32 v36, 0xbfb8aa3b, v36
  v_mul_f32 v37, 0xbfb8aa3b, v37
  v_mul_f32 v38, 0xbfb8aa3b, v38
  v_exp_f32 v36, v36
  v_exp_f32 v37, v37
  v_exp_f32 v38, v38
  s_nop 0
  v_add_f32 v36, 1.0, v36
  v_add_f32 v37, 1.0, v37
  v_add_f32 v38, 1.0, v38
  v_rcp_f32 v36, v36
  v_rcp_f32 v37, v37
  v_rcp_f32 v38, v38
  s_nop 0
  v_mul_f32 v36, v36, v40
  v_mul_f32 v36, v36, v13
  v_cvt_pk_bf16_f32 v36, v36, v36
  v_mul_f32 v37, v37, v41
  v_mul_f32 v37, v37, v13
  v_cvt_pk_bf16_f32 v37, v37, v37
  v_mul_f32 v38, v38, v42
  v_mul_f32 v38, v38, v13
  v_cvt_pk_bf16_f32 v38, v38, v38
  v_and_b32 v10, 0xfffffff3, v3
  v_bfe_u32 v11, v3, 2, 1
  v_lshl_or_b32 v10, v11, 3, v10
  v_bfe_u32 v11, v3, 3, 1
  v_lshl_or_b32 v10, v11, 2, v10
  v_lshlrev_b32 v10, 1, v10
  v_add_u32 v10, 140160, v10
  v_lshlrev_b32 v11, 1, v3
  v_add_u32 v11, 140224, v11
  s_mov_b64 exec, 0xffff
  ds_write_b16 v10, v36
  ds_write_b16 v10, v37 offset:32
  ds_write_b16 v11, v38
  s_mov_b64 exec, -1
  v_mov_b32 v14, 163712
  s_mov_b64 exec, 1
  ds_add_u32 v14, v16
  s_mov_b64 exec, -1
  s_branch L_s5
L_b1:
  v_mul_u32_u24 v10, 96, v8
  v_lshl_add_u32 v10, v5, 3, v10
  s_sub_u32 s62, s4, 4
  s_mul_i32 s63, s62, 7680
  s_add_u32 s63, s63, 124416
  v_add_u32 v82, s63, v10
  s_lshl_b32 s62, s62, 8
  s_add_u32 s62, s62, s60
  s_add_u32 s64, s62, 1024
  v_mov_b32 v14, 163732
L_gl_17:
  ds_read_b32 v15, v14
  s_waitcnt lgkmcnt(0)
  v_readfirstlane_b32 s71, v15
  s_cmp_eq_u32 s71, 0
  s_cbranch_scc1 L_gl_17
  v_mov_b32 v14, 163664
L_wf_18:
  ds_read_b32 v15, v14 offset:80
  s_waitcnt lgkmcnt(0)
  v_cmp_gt_u32 vcc, 2, v15
  s_cbranch_vccnz L_wf_18
  ds_read_b64_tr_b16 v[84:85], v82 offset:0
  ds_read_b64_tr_b16 v[86:87], v82 offset:32
  ds_read_b64_tr_b16 v[88:89], v82 offset:64
  ds_read_b64_tr_b16 v[90:91], v82 offset:1536
  ds_read_b64_tr_b16 v[92:93], v82 offset:1568
  ds_read_b64_tr_b16 v[94:95], v82 offset:1600
  ds_read_b64_tr_b16 v[96:97], v82 offset:3072
  ds_read_b64_tr_b16 v[98:99], v82 offset:3104
  ds_read_b64_tr_b16 v[100:101], v82 offset:3136
  ds_read_b64_tr_b16 v[102:103], v82 offset:4608
  ds_read_b64_tr_b16 v[104:105], v82 offset:4640
  ds_read_b64_tr_b16 v[106:107], v82 offset:4672
  ds_read_b64_tr_b16 v[108:109], v82 offset:6144
  ds_read_b64_tr_b16 v[110:111], v82 offset:6176
  ds_read_b64_tr_b16 v[112:113], v82 offset:6208
  s_waitcnt lgkmcnt(12)
  v_mfma_f32_16x16x16_bf16 v[24:27], v[72:73], v[84:85], 0
  v_mfma_f32_16x16x16_bf16 v[28:31], v[72:73], v[86:87], 0
  v_mfma_f32_16x16x16_bf16 v[32:35], v[72:73], v[88:89], 0
  s_waitcnt lgkmcnt(9)
  v_mfma_f32_16x16x16_bf16 v[24:27], v[74:75], v[90:91], v[24:27]
  v_mfma_f32_16x16x16_bf16 v[28:31], v[74:75], v[92:93], v[28:31]
  v_mfma_f32_16x16x16_bf16 v[32:35], v[74:75], v[94:95], v[32:35]
  s_waitcnt lgkmcnt(6)
  v_mfma_f32_16x16x16_bf16 v[24:27], v[76:77], v[96:97], v[24:27]
  v_mfma_f32_16x16x16_bf16 v[28:31], v[76:77], v[98:99], v[28:31]
  v_mfma_f32_16x16x16_bf16 v[32:35], v[76:77], v[100:101], v[32:35]
  s_waitcnt lgkmcnt(3)
  v_mfma_f32_16x16x16_bf16 v[24:27], v[78:79], v[102:103], v[24:27]
  v_mfma_f32_16x16x16_bf16 v[28:31], v[78:79], v[104:105], v[28:31]
  v_mfma_f32_16x16x16_bf16 v[32:35], v[78:79], v[106:107], v[32:35]
  s_waitcnt lgkmcnt(0)
  v_mfma_f32_16x16x16_bf16 v[24:27], v[80:81], v[108:109], v[24:27]
  v_mfma_f32_16x16x16_bf16 v[28:31], v[80:81], v[110:111], v[28:31]
  v_mfma_f32_16x16x16_bf16 v[32:35], v[80:81], v[112:113], v[32:35]
  v_mov_b32 v23, s11
  s_nop 7
  v_mov_b32 v20, v24
  v_mov_b32 v21, v28
  v_mov_b32 v22, v32
  s_mov_b64 exec, 0xffff
  s_cmp_eq_u32 s71, 1
  s_cbranch_scc1 L_ls_19_pl
  buffer_store_dwordx4 v[20:23], v6, s[44:47], s64 offen sc1
  s_branch L_ls_19_e
L_ls_19_pl:
  buffer_store_dwordx4 v[20:23], v6, s[44:47], s64 offen
L_ls_19_e:
  s_mov_b64 exec, -1
  s_cmp_eq_u32 s4, 5
  s_cbranch_scc1 L_red
L_s5:
  v_lshlrev_b32 v150, 4, v2
  v_add_u32 v150, 139776, v150
  v_lshlrev_b32 v151, 3, v2
  v_add_u32 v151, 140224, v151
  v_mul_u32_u24 v10, 160, v7
  s_lshl_b32 s62, s4, 5
  s_add_u32 s62, s62, 86016
  v_lshl_add_u32 v11, v5, 3, s62
  v_add_u32 v148, v10, v11
  v_mul_u32_u24 v10, 160, v8
  v_add_u32 v149, v10, v11
  s_mul_i32 s62, s8, 5
  s_add_u32 s62, s62, s4
  s_lshl_b32 s62, s62, 5
  s_add_u32 s62, s62, s7
  s_lshl_b32 s62, s62, 7
  s_add_u32 s64, s62, 655360
  v_mov_b32 v14, 163664
L_wf_20:
  ds_read_b32 v15, v14 offset:52
  s_waitcnt lgkmcnt(0)
  v_cmp_gt_u32 vcc, 2, v15
  s_cbranch_vccnz L_wf_20
  ds_read_b64_tr_b16 v[116:117], v148 offset:0
  ds_read_b64_tr_b16 v[118:119], v148 offset:1280
  ds_read_b64_tr_b16 v[120:121], v148 offset:5120
  ds_read_b64_tr_b16 v[122:123], v148 offset:6400
  ds_read_b64_tr_b16 v[124:125], v148 offset:10240
  ds_read_b64_tr_b16 v[126:127], v148 offset:11520
  ds_read_b64_tr_b16 v[128:129], v148 offset:15360
  ds_read_b64_tr_b16 v[130:131], v148 offset:16640
  ds_read_b64_tr_b16 v[132:133], v148 offset:20480
  ds_read_b64_tr_b16 v[134:135], v148 offset:21760
  ds_read_b64_tr_b16 v[136:137], v148 offset:25600
  ds_read_b64_tr_b16 v[138:139], v148 offset:26880
  s_waitcnt lgkmcnt(4)
  ds_read_b64_tr_b16 v[140:141], v148 offset:30720
  ds_read_b64_tr_b16 v[142:143], v148 offset:32000
  ds_read_b64_tr_b16 v[144:145], v149 offset:35840
  v_mov_b32 v14, 163664
L_wf_21:
  ds_read_b32 v15, v14 offset:48
  s_waitcnt lgkmcnt(0)
  v_cmp_gt_u32 vcc, 2, v15
  s_cbranch_vccnz L_wf_21
  ds_read_b128 v[84:87], v150 offset:0
  ds_read_b128 v[88:91], v150 offset:64
  ds_read_b128 v[92:95], v150 offset:128
  ds_read_b128 v[96:99], v150 offset:192
  ds_read_b128 v[100:103], v150 offset:256
  ds_read_b128 v[104:107], v150 offset:320
  ds_read_b128 v[108:111], v150 offset:384
  ds_read_b64 v[112:113], v151
  s_waitcnt lgkmcnt(7)
  v_mfma_f32_16x16x32_bf16 v[24:27], v[84:87], v[116:119], 0
  s_waitcnt lgkmcnt(6)
  v_mfma_f32_16x16x32_bf16 v[24:27], v[88:91], v[120:123], v[24:27]
  s_waitcnt lgkmcnt(5)
  v_mfma_f32_16x16x32_bf16 v[24:27], v[92:95], v[124:127], v[24:27]
  s_waitcnt lgkmcnt(4)
  v_mfma_f32_16x16x32_bf16 v[24:27], v[96:99], v[128:131], v[24:27]
  s_waitcnt lgkmcnt(3)
  v_mfma_f32_16x16x32_bf16 v[24:27], v[100:103], v[132:135], v[24:27]
  s_waitcnt lgkmcnt(2)
  v_mfma_f32_16x16x32_bf16 v[24:27], v[104:107], v[136:139], v[24:27]
  s_waitcnt lgkmcnt(1)
  v_mfma_f32_16x16x32_bf16 v[24:27], v[108:111], v[140:143], v[24:27]
  s_waitcnt lgkmcnt(0)
  v_mfma_f32_16x16x16_bf16 v[28:31], v[112:113], v[144:145], 0
  v_lshlrev_b32 v10, 3, v1
  v_mov_b32 v21, s11
  s_nop 7
  v_add_f32 v20, v24, v28
  s_mov_b64 exec, 0xffff
  buffer_store_dwordx2 v[20:21], v10, s[44:47], s64 offen sc1
  s_mov_b64 exec, -1
  s_cmp_eq_u32 s4, 0
  s_cbranch_scc0 L_fin
  s_cmp_lt_u32 s2, 40
  s_cbranch_scc0 L_fin
  s_waitcnt vmcnt(0)
  v_mov_b32 v14, 163736
  s_mov_b64 exec, 1
  ds_add_u32 v14, v16
  s_mov_b64 exec, -1
  s_branch L_fin
L_red:
  s_cmp_lt_u32 s2, 40
  s_cbranch_scc0 L_fin
  s_lshl_b32 s62, s2, 12
  s_add_u32 s62, s62, 655360
  v_mov_b32 v14, 163664
L_wf_22:
  ds_read_b32 v15, v14 offset:72
  s_waitcnt lgkmcnt(0)
  v_cmp_gt_u32 vcc, 1, v15
  s_cbranch_vccnz L_wf_22
  s_mov_b32 s68, 200000
  buffer_load_dwordx4 v[36:39], v6, s[44:47], s62 offen offset:0 sc1
  buffer_load_dwordx4 v[40:43], v6, s[44:47], s62 offen offset:1024 sc1
  buffer_load_dwordx4 v[44:47], v6, s[44:47], s62 offen offset:2048 sc1
  buffer_load_dwordx4 v[48:51], v6, s[44:47], s62 offen offset:3072 sc1
  s_branch L_h6_w
L_h6:
  v_cmp_ne_u32 vcc, s11, v37
  v_cmp_ne_u32 s[66:67], s11, v39
  s_or_b64 vcc, vcc, s[66:67]
  s_cbranch_scc0 L_h6_s0
  buffer_load_dwordx4 v[36:39], v6, s[44:47], s62 offen offset:0 sc1
L_h6_s0:
  v_cmp_ne_u32 vcc, s11, v41
  v_cmp_ne_u32 s[66:67], s11, v43
  s_or_b64 vcc, vcc, s[66:67]
  s_cbranch_scc0 L_h6_s1
  buffer_load_dwordx4 v[40:43], v6, s[44:47], s62 offen offset:1024 sc1
L_h6_s1:
  v_cmp_ne_u32 vcc, s11, v45
  v_cmp_ne_u32 s[66:67], s11, v47
  s_or_b64 vcc, vcc, s[66:67]
  s_cbranch_scc0 L_h6_s2
  buffer_load_dwordx4 v[44:47], v6, s[44:47], s62 offen offset:2048 sc1
L_h6_s2:
  v_cmp_ne_u32 vcc, s11, v49
  v_cmp_ne_u32 s[66:67], s11, v51
  s_or_b64 vcc, vcc, s[66:67]
  s_cbranch_scc0 L_h6_s3
  buffer_load_dwordx4 v[48:51], v6, s[44:47], s62 offen offset:3072 sc1
L_h6_s3:
L_h6_w:
  s_waitcnt vmcnt(0)
  v_xor_b32 v9, s11, v37
  v_bitop3_b32 v9, v9, v41, s11 bitop3:0xf6
  v_bitop3_b32 v9, v9, v45, s11 bitop3:0xf6
  v_bitop3_b32 v9, v9, v49, s11 bitop3:0xf6
  v_bitop3_b32 v9, v9, v39, s11 bitop3:0xf6
  v_bitop3_b32 v9, v9, v43, s11 bitop3:0xf6
  v_bitop3_b32 v9, v9, v47, s11 bitop3:0xf6
  v_bitop3_b32 v9, v9, v51, s11 bitop3:0xf6
  v_cmp_ne_u32 vcc, 0, v9
  s_cbranch_vccz L_h6_ok
  s_sub_u32 s68, s68, 1
  s_cbranch_scc0 L_h6
L_h6_ok:
  v_add_f32 v36, v36, v40
  v_add_f32 v44, v44, v48
  v_add_f32 v36, v36, v44
  v_add_f32 v38, v38, v42
  v_add_f32 v46, v46, v50
  v_add_f32 v38, v38, v46
  s_nop 1
  v_add_f32_dpp v36, v36, v36 row_ror:8 row_mask:0xf bank_mask:0xf
  s_nop 1
  v_add_f32_dpp v38, v38, v38 row_ror:8 row_mask:0xf bank_mask:0xf
  v_mov_b32 v40, v36
  v_mov_b32 v42, v38
  s_nop 1
  v_permlane16_swap_b32 v36, v40
  v_permlane16_swap_b32 v38, v42
  s_nop 1
  v_add_f32 v36, v36, v40
  v_add_f32 v38, v38, v42
  v_mov_b32 v40, v36
  v_mov_b32 v42, v38
  s_nop 1
  v_permlane32_swap_b32 v36, v40
  v_permlane32_swap_b32 v38, v42
  s_nop 1
  v_add_f32 v36, v36, v40
  v_add_f32 v38, v38, v42
  v_cvt_pk_bf16_f32 v36, v36, v38
  v_lshlrev_b32 v10, 2, v1
  s_lshl_b32 s62, s2, 5
  s_mov_b64 exec, 0xff
  buffer_store_dword v36, v10, s[48:51], s62 offen sc1
  s_cmp_eq_u32 s2, 0
  s_cbranch_scc0 L_noep
  v_mov_b32 v11, s11
  v_mov_b32 v10, 0
  s_mov_b64 exec, 1
  buffer_store_dword v11, v10, s[44:47], 0 offen sc1
L_noep:
  s_mov_b64 exec, -1
L_fin:
  s_endpgm
L_end:
  s_endpgm
.section .rodata,"a"
.p2align 6
.amdhsa_kernel gated_mix__compressed_kv_cla__glu_gated_glu__decode_kernel
  .amdhsa_next_free_vgpr 160
  .amdhsa_next_free_sgpr 102
  .amdhsa_accum_offset 160
  .amdhsa_group_segment_fixed_size 0
  .amdhsa_kernarg_size 112
  .amdhsa_user_sgpr_count 2
  .amdhsa_user_sgpr_kernarg_segment_ptr 1
  .amdhsa_system_sgpr_workgroup_id_x 1
.end_amdhsa_kernel
```
